```python
import torch

def _softmax(x, axis=-1):
    return torch.softmax(x, dim=axis)
def _gelu(x):
    return torch.nn.functional.gelu(x, approximate="tanh")
def _silu(x):
    return torch.nn.functional.silu(x)
def _sigmoid(x):
    return torch.sigmoid(x)
def _layernorm(x, axis=-1, eps=1e-5):
    m = x.mean(dim=axis, keepdim=True)
    v = x.var(dim=axis, keepdim=True, unbiased=False)
    return (x - m) / torch.sqrt(v + eps)
def _scatter_add(tgt, idx, src, axis=0):
    return tgt.clone().index_add_(axis, idx, src)
def _segment_sum(src, seg, n):
    out = torch.zeros((n,) + src.shape[1:], dtype=src.dtype)
    return out.index_add_(0, seg, src)
def _pad(x, pw):
    flat = tuple(v for pair in reversed(pw) for v in pair)
    return torch.nn.functional.pad(x, flat)

kernel_name = 'parallel_sum__sliding_local_dilated__moe_arch_mod__prompt'

def setup_inputs():

    _w = (lambda a: (lambda t: t.to(torch.bfloat16) if t.is_floating_point() else t)(torch.as_tensor(a)))
    def _A_setup():
        B, S, D = 1, 2048, 640
        return {
            "x": _w((lambda *s: torch.randn(*s, dtype=torch.bfloat16) * 0.05)(B, S, D)),
            "wqkv": _w((lambda *s: torch.randn(*s, dtype=torch.bfloat16) * 0.05)(D, 3 * D)),
            "wo": _w((lambda *s: torch.randn(*s, dtype=torch.bfloat16) * 0.05)(D, D)),
        }
    _A_in = _A_setup()

    def _B_setup():
        B, S, D, F, C = 1, 2048, 640, 1536, 2
        return {
            "x": _w((lambda *s: torch.randn(*s, dtype=torch.bfloat16) * 0.05)(B, S, D)),
            "w_r": _w((lambda *s: torch.randn(*s, dtype=torch.bfloat16) * 0.05)(D)),
            "w_gate": _w((lambda *s: torch.randn(*s, dtype=torch.bfloat16) * 0.05)(D, F)),
            "w_up": _w((lambda *s: torch.randn(*s, dtype=torch.bfloat16) * 0.05)(D, F)),
            "w_down": _w((lambda *s: torch.randn(*s, dtype=torch.bfloat16) * 0.05)(F, D)),
        }
    _B_in = _B_setup()

    return {
        "A_x": _A_in["x"],
        "A_wqkv": _A_in["wqkv"],
        "A_wo": _A_in["wo"],
        "B_x": _B_in["x"],
        "B_w_r": _B_in["w_r"],
        "B_w_gate": _B_in["w_gate"],
        "B_w_up": _B_in["w_up"],
        "B_w_down": _B_in["w_down"],
    }

def reference(A_x, A_wqkv, A_wo, B_x, B_w_r, B_w_gate, B_w_up, B_w_down):
    def _A_ref(x, wqkv, wo):
        B, S, D = x.shape
        H = 32; Dh = D // H
        W, dil = 8, 2
        qkv = (lambda x, *d: x.permute(*d))((x @ wqkv).reshape(B, S, 3, H, Dh), 2, 0, 3, 1, 4)
        q, k, v = qkv[0], qkv[1], qkv[2]
        scale = Dh ** -0.5
        pos = torch.arange(S)
        off = torch.arange(W) * dil
        idx = pos[:, None] - off[None, :]
        mask = idx >= 0
        idx_c = torch.where(mask, idx, 0).reshape(-1)
        kg = k[:, :, idx_c, :].reshape(B, H, S, W, Dh)
        vg = v[:, :, idx_c, :].reshape(B, H, S, W, Dh)
        logits = torch.einsum("bhsd,bhswd->bhsw", q, kg) * scale
        logits = torch.where(mask[None, None, :, :], logits, -1e9)
        attn = _softmax(logits, axis=-1)
        o = torch.einsum("bhsw,bhswd->bhsd", attn, vg)
        return (lambda x, *d: x.permute(*d))(o, 0, 2, 1, 3).reshape(B, S, D) @ wo

    def _B_ref(x, w_r, w_gate, w_up, w_down):
        B, S, D = x.shape
        C = 2
        r = x @ w_r
        idx = torch.argsort(-r, axis=-1)[:, :C]
        idx_e = (lambda x, n, axis: torch.repeat_interleave(x, n, dim=axis))(idx.reshape(B, C, 1), D, axis=2)
        x_sel = (lambda x, i, axis: torch.take_along_dim(x, i, dim=axis))(x, idx_e, axis=1)
        g = _silu(x_sel @ w_gate)
        u = x_sel @ w_up
        y = (g * u) @ w_down
        r_sel = _sigmoid((lambda x, i, axis: torch.take_along_dim(x, i, dim=axis))(r, idx, axis=1))
        y = y * r_sel.reshape(B, C, 1)
        b_off = (torch.arange(B) * S).reshape(B, 1)
        flat_idx = (idx + b_off).reshape(B * C)
        zero = (x * 0.0).reshape(B * S, D)
        upd = _scatter_add(zero, flat_idx, y.reshape(B * C, D), axis=0)
        return x + upd.reshape(B, S, D)

    x = A_x
    xn = _layernorm(x, axis=-1)
    return x + _A_ref(xn, A_wqkv, A_wo) + _B_ref(xn, B_w_r, B_w_gate, B_w_up, B_w_down)
```

```asm
; @launch grid=(256,1,1) block=(512,1,1) lds=163840
.amdgcn_target "amdgcn-amd-amdhsa--gfx950"
.text
.globl parallel_sum__sliding_local_dilated__moe_arch_mod__prompt_kernel
.p2align 8
.type parallel_sum__sliding_local_dilated__moe_arch_mod__prompt_kernel,@function
parallel_sum__sliding_local_dilated__moe_arch_mod__prompt_kernel:
    s_cmp_ge_u32 s2, 256
    s_cbranch_scc1 K_end
    s_nop 0
    s_load_dwordx16 s[64:79], s[0:1], 0
    s_load_dwordx2 s[80:81], s[0:1], 64
    s_load_dwordx2 s[84:85], s[0:1], 80
    s_cmp_lt_u32 s2, 160
    s_cbranch_scc1 EN_nopf
    s_getpc_b64 s[48:49]
    s_and_b32 s48, s48, 0xffffff00
    v_lshlrev_b32 v7, 7, v0
    v_cmp_gt_u32 vcc, 142, v0
    s_nop 0
    s_and_saveexec_b64 s[50:51], vcc
    s_cbranch_execz EN_nopf2
    global_load_dword v31, v7, s[48:49]
    v_add_u32 v7, 18176, v7
    global_load_dword v31, v7, s[48:49]
EN_nopf2:
    s_mov_b64 exec, s[50:51]
EN_nopf:
    v_lshrrev_b32 v1, 6, v0
    v_and_b32 v2, 63, v0
    v_readfirstlane_b32 s3, v1
    s_mov_b32 s7, 0xffff0000
    s_and_b32 s4, s2, 7
    s_lshr_b32 s5, s2, 3
    s_and_b32 s44, s4, 1
    s_lshl_b32 s44, s44, 2
    s_and_b32 s6, s5, 3
    s_add_u32 s44, s44, s6
    s_lshr_b32 s47, s4, 1
    s_mul_i32 s47, s47, 5
    s_lshr_b32 s6, s5, 2
    s_add_u32 s47, s47, s6
    s_lshr_b32 s45, s4, 2
    s_mul_i32 s6, s45, 10
    s_sub_u32 s6, s47, s6
    s_mul_i32 s46, s6, 104
    v_lshrrev_b32 v3, 4, v2
    v_bfe_u32 v4, v2, 2, 2
    v_and_b32 v5, 3, v2
    v_and_b32 v6, 15, v2
    s_cmp_ge_u32 s5, 20
    s_cbranch_scc1 K_other
    s_cmp_ge_u32 s3, 4
    s_cbranch_scc1 K_C
    s_cmp_ge_u32 s5, 15
    s_cbranch_scc1 PF_xl
    s_lshl_b32 s48, s5, 6
    v_add_u32 v9, s48, v2
    v_mul_u32_u24 v10, 4370, v9
    v_lshrrev_b32 v10, 16, v10
    v_mul_u32_u24 v11, 15, v10
    v_sub_u32 v9, v9, v11
    v_mul_u32_u24 v11, 52, v9
    v_lshrrev_b32_e64 v11, 8, v11
    v_mul_u32_u24 v10, 3840, v10
    v_mul_u32_u24 v11, 640, v11
    v_lshl_add_u32 v8, v9, 7, v10
    s_and_b32 s48, s4, 1
    s_mul_i32 s48, s48, 640
    v_add3_u32 v8, v8, v11, s48
    s_mov_b32 s50, 1
    s_branch PF_el
PF_xl:
    s_cmp_ge_u32 s5, 20
    s_cselect_b32 s48, 20, 15
    s_cselect_b32 s49, 0, 1
    s_sub_u32 s48, s5, s48
    s_lshl_b32 s48, s48, 6
    s_xor_b32 s49, s4, s49
    s_and_b32 s49, s49, 3
    s_lshl_b32 s49, s49, 8
    s_add_u32 s48, s48, s49
    s_cmp_eq_u32 s5, 19
    s_cselect_b32 s48, 512, s48
    s_cselect_b32 s49, 15, 63
    v_and_b32 v9, s49, v2
    v_add_u32 v9, s48, v9
    v_mul_u32_u24 v9, 2560, v9
    s_mul_i32 s48, s45, 1280
    v_add_u32_e64 v8, s48, v9
    s_mov_b32 s50, 0
PF_el:
    s_mov_b32 s83, s50
    s_waitcnt lgkmcnt(0)
    s_mov_b32 s8, s64
    s_and_b32 s9, s65, 0xffff
    s_mov_b32 s10, 0x280000
    s_mov_b32 s11, 0x20000
    s_mov_b32 s12, s66
    s_nop 0
    s_and_b32 s13, s67, 0xffff
    s_mov_b32 s14, 0x258000
    s_mov_b32 s15, 0x20000
    s_cmp_ge_u32 s3, 2
    s_cbranch_scc1 P1L_nopf
    s_cmp_eq_u32 s50, 0
    s_cbranch_scc1 PI_xl
    s_mul_i32 s48, s3, 245760
    buffer_load_dword v31, v8, s[12:15], s48 offen
    s_branch PI_el
PI_xl:
    s_lshl_b32 s48, s3, 7
    buffer_load_dword v31, v8, s[8:11], s48 offen
PI_el:
P1L_nopf:
    v_lshrrev_b32 v50, 3, v2
    s_lshl_b32 s6, s3, 3
    v_add_u32 v50, s6, v50
    v_lshrrev_b32 v51, 1, v50
    v_xor_b32 v51, v51, v2
    v_and_b32 v51, 7, v51
    v_lshlrev_b32 v51, 4, v51
    s_mul_i32 s6, s45, 1280
    v_add_u32 v51, s6, v51
    s_sub_u32 s6, s46, 8
    v_add_u32 v50, s6, v50
    s_movk_i32 s49, 2560
    v_mov_b32 v53, 0x80000000
    v_add_u32 v52, 0, v50
    v_mad_u32_u24 v148, v52, s49, v51
    v_cmp_gt_u32 vcc, 1024, v52
    s_nop 1
    v_cndmask_b32 v148, v53, v148, vcc
    v_add_u32_e64 v52, 32, v50
    v_mad_u32_u24 v149, v52, s49, v51
    v_cmp_gt_u32 vcc, 1024, v52
    s_nop 1
    v_cndmask_b32 v149, v53, v149, vcc
    v_add_u32_e64 v52, 64, v50
    v_mad_u32_u24 v150, v52, s49, v51
    v_cmp_gt_u32 vcc, 1024, v52
    s_nop 1
    v_cndmask_b32 v150, v53, v150, vcc
    v_add_u32 v52, 96, v50
    v_mad_u32_u24 v151, v52, s49, v51
    s_cmp_lt_u32 s3, 2
    s_cselect_b32 s6, 1024, 0
    v_cmp_gt_u32 vcc, s6, v52
    s_nop 1
    v_cndmask_b32 v151, v53, v151, vcc
    s_lshl_b32 s54, s3, 10
    s_add_u32 s54, s54, 65536
    s_cmp_eq_u32 s3, 0
    s_cselect_b32 s56, 0xffffff00, -1
    s_mov_b32 s57, -1
    s_and_b32 s50, s3, 1
    s_lshr_b32 s51, s3, 1
    s_lshl_b32 s53, s51, 2
    s_add_u32 s53, s53, s50
    s_add_u32 s51, s53, s50
    v_lshrrev_b32 v50, 5, v2
    v_add_u32 v51, s51, v50
    v_lshlrev_b32 v51, 1, v51
    v_sub_u32 v51, v2, v51
    v_and_b32 v51, 31, v51
    v_mul_u32_u24 v52, 47, v51
    v_lshrrev_b32 v52, 9, v52
    v_mul_u32_u24 v54, 11, v52
    v_sub_u32_e64 v54, v51, v54
    v_mul_u32_u24 v52, 1280, v52
    v_lshl_add_u32 v52, v54, 4, v52
    s_lshl_b32 s51, s53, 1
    v_add_u32 v50, s51, v50
    v_mul_u32_u24 v50, 3840, v50
    s_mul_i32 s51, s44, 160
    v_add3_u32 v131, v50, v52, s51
    v_cmp_gt_u32 vcc, 10, v54
    s_nop 1
    v_cndmask_b32 v131, v53, v131, vcc
    s_and_b32 s51, s44, 3
    s_lshl_b32 s51, s51, 1
    s_sub_u32 s51, 8, s51
    v_cmp_le_u32 vcc, s51, v54
    v_mov_b32 v50, 61440
    v_add_u32 v139, v50, v131
    v_cndmask_b32 v50, 0, v50, vcc
    v_sub_u32 v139, v139, v50
    v_add_u32 v131, v131, v50
    s_lshl_b32 s55, s53, 10
    s_mov_b32 s52, 0
    s_mov_b32 s53, 0
    s_waitcnt lgkmcnt(0)
    s_mov_b32 s8, s64
    s_and_b32 s9, s65, 0xffff
    s_mov_b32 s10, 0x280000
    s_mov_b32 s11, 0x20000
    s_mov_b32 s12, s66
    s_nop 0
    s_and_b32 s13, s67, 0xffff
    s_mov_b32 s14, 0x258000
    s_mov_b32 s15, 0x20000
    s_add_u32 m0, s54, 0
    s_mov_b64 exec, s[56:57]
    buffer_load_dwordx4 v148, s[8:11], s52 offen lds
    s_mov_b64 exec, -1
    s_add_u32 m0, s54, 4096
    s_nop 0
    buffer_load_dwordx4 v149, s[8:11], s52 offen lds
    s_add_u32 m0, s54, 8192
    s_nop 0
    buffer_load_dwordx4 v150, s[8:11], s52 offen lds
    s_add_u32 m0, s54, 12288
    s_nop 0
    buffer_load_dwordx4 v151, s[8:11], s52 offen lds
    s_add_u32 s52, s52, 128
    s_add_u32 s48, s84, 0x18000
    s_addc_u32 s49, s85, 0
    s_load_dword s60, s[48:49], 0
    s_mul_i32 s6, s4, 27
    s_add_u32 s6, s6, s5
    s_mul_i32 s61, s6, 205
    s_lshr_b32 s61, s61, 10
    s_mul_i32 s62, s61, 5
    s_sub_u32 s62, s6, s62
    s_cmp_lt_u32 s6, 215
    s_cselect_b32 s63, 1, 0
    s_cmp_lt_u32 s5, 27
    s_cselect_b32 s63, s63, 0
    s_and_b32 s40, s3, 3
    s_mul_i32 s42, s61, 48
    s_lshl_b32 s43, s62, 8
    s_lshl_b32 s6, s40, 6
    s_add_u32 s43, s43, s6
    s_mov_b32 s20, s68
    s_nop 0
    s_and_b32 s21, s69, 0xffff
    s_mov_b32 s22, 0xc8000
    s_mov_b32 s23, 0x20000
    s_mov_b32 s16, s84
    s_nop 0
    s_and_b32 s17, s85, 0xffff
    s_mov_b32 s18, 0x10000000
    s_mov_b32 s19, 0x20000
    s_mov_b32 s24, s80
    s_nop 0
    s_and_b32 s25, s81, 0xffff
    s_mov_b32 s26, 0x280000
    s_mov_b32 s27, 0x20000
    s_lshr_b32 s48, s3, 1
    s_lshl_b32 s48, s48, 2
    v_add_u32 v50, s48, v3
    v_lshlrev_b32 v50, 1, v50
    v_sub_u32 v50, v2, v50
    v_and_b32 v50, 15, v50
    s_lshl_b32 s48, s3, 2
    v_add_u32 v51, s48, v3
    v_mul_u32_u24 v51, 1280, v51
    v_lshl_add_u32 v51, v50, 4, v51
    s_lshl_b32 s48, s62, 8
    v_add_u32 v133, s48, v51
    s_lshl_b32 s58, s3, 10
    s_add_u32 s48, s61, 0
    s_and_b32 s48, s48, 3
    s_mul_i32 s28, s48, 204800
    s_add_u32 s48, s61, 1
    s_and_b32 s48, s48, 3
    s_mul_i32 s29, s48, 204800
    s_add_u32 s48, s61, 2
    s_and_b32 s48, s48, 3
    s_mul_i32 s30, s48, 204800
    s_add_u32 s48, s61, 3
    s_and_b32 s48, s48, 3
    s_nop 0
    s_mul_i32 s31, s48, 204800
    s_mul_i32 s49, s3, 5120
    v_lshl_add_u32 v145, v2, 4, s49
    v_add_u32 v1, s42, v6
    v_and_b32 v20, 1, v3
    v_lshlrev_b32 v20, 5, v20
    v_lshrrev_b32 v21, 1, v3
    v_lshl_add_u32 v20, v21, 4, v20
    v_add_u32 v20, s43, v20
    v_mov_b32 v23, 0x80000000
    s_movk_i32 s51, 1280
    v_add_u32 v21, 0, v1
    v_cmp_gt_u32 vcc, 2048, v21
    v_lshrrev_b32 v22, 10, v21
    v_and_b32 v21, 1023, v21
    v_lshl_add_u32 v21, v21, 1, v22
    v_mad_u32_u24 v21, v21, s51, v20
    v_cndmask_b32 v7, v23, v21, vcc
    v_add_u32 v21, 16, v1
    v_cmp_gt_u32 vcc, 2048, v21
    v_lshrrev_b32_e64 v22, 10, v21
    v_and_b32 v21, 1023, v21
    v_lshl_add_u32 v21, v21, 1, v22
    v_mad_u32_u24 v21, v21, s51, v20
    v_cndmask_b32 v8, v23, v21, vcc
    v_add_u32 v21, 32, v1
    v_cmp_gt_u32 vcc, 2048, v21
    v_lshrrev_b32_e64 v22, 10, v21
    v_and_b32 v21, 1023, v21
    v_lshl_add_u32 v21, v21, 1, v22
    v_mad_u32_u24 v21, v21, s51, v20
    v_cndmask_b32 v9, v23, v21, vcc
    s_mov_b32 s50, s42
    s_add_u32 s51, s50, 47
    s_min_u32 s51, s51, 2047
    s_lshr_b32 s6, s50, 10
    s_mul_i32 s6, s6, 10
    s_and_b32 s50, s50, 1023
    s_mul_i32 s50, s50, 2521
    s_lshr_b32 s50, s50, 18
    s_add_u32 s50, s50, s6
    s_lshr_b32 s6, s51, 10
    s_mul_i32 s6, s6, 10
    s_and_b32 s51, s51, 1023
    s_mul_i32 s51, s51, 2521
    s_lshr_b32 s51, s51, 18
    s_add_u32 s51, s51, s6
    s_sub_u32 s51, s51, s50
    s_lshl_b32 s51, s51, 10
    v_bfe_u32 v50, v2, 2, 1
    v_mul_u32_u24 v50, s51, v50
    v_bfe_u32 v51, v2, 3, 1
    v_lshl_add_u32 v50, v51, 7, v50
    s_lshl_b32 s50, s50, 2
    s_add_u32 s50, s50, s3
    s_lshl_b32 s50, s50, 8
    s_add_u32 s50, s50, 0x60000
    s_mul_i32 s51, s62, 24576
    s_add_u32 s50, s50, s51
    v_add_u32_e64 v138, s50, v50
    s_mul_i32 s50, s3, 655360
    s_mul_i32 s51, s61, 7680
    s_add_u32 s50, s50, s51
    s_nop 0
    s_add_u32 s50, s50, 0x100000
    v_lshl_add_u32 v140, v2, 4, s50
    v_add_u32 v141, 1024, v140
    v_add_u32 v50, 2048, v140
    v_add_u32 v51, 0x4fe00, v140
    v_cmp_gt_u32 vcc, 32, v2
    s_nop 1
    v_cndmask_b32_e64 v142, v51, v50, vcc
    v_add_u32 v143, 0x50200, v140
    v_add_u32 v144, 0x50600, v140
    s_lshl_b32 s50, s3, 2
    v_add_u32 v50, s50, v3
    v_xor_b32 v51, v50, v2
    v_and_b32 v51, 15, v51
    s_lshl_b32 s50, s62, 8
    v_lshl_add_u32 v51, v51, 4, s50
    v_add_u32 v50, s42, v50
    s_movk_i32 s51, 1280
    v_add_u32 v52, 0, v50
    v_min_u32 v52, 2047, v52
    v_lshrrev_b32_e64 v54, 10, v52
    v_and_b32 v52, 1023, v52
    v_lshl_add_u32 v52, v52, 1, v54
    v_mad_u32_u24 v134, v52, s51, v51
    v_add_u32 v52, 16, v50
    v_min_u32 v52, 2047, v52
    v_lshrrev_b32 v54, 10, v52
    v_and_b32 v52, 1023, v52
    v_lshl_add_u32 v52, v52, 1, v54
    v_mad_u32_u24 v135, v52, s51, v51
    v_add_u32 v52, 32, v50
    v_min_u32 v52, 2047, v52
    v_lshrrev_b32 v54, 10, v52
    v_and_b32 v52, 1023, v52
    v_lshl_add_u32 v52, v52, 1, v54
    v_mad_u32_u24 v136, v52, s51, v51
    s_lshl_b32 s50, s42, 3
    v_lshl_add_u32 v137, v2, 4, s50
    v_lshlrev_b32 v50, 1, v2
    s_sub_u32 s6, s46, 8
    v_add_u32 v50, s6, v50
    s_lshl_b32 s6, s45, 10
    s_movk_i32 s48, 1022
    v_med3_i32 v50, v50, 0, s48
    v_add_lshl_u32 v132, v50, s6, 3
    s_add_u32 m0, s55, 0
    s_add_u32 s51, s53, 0
    buffer_load_dwordx4 v131, s[12:15], s51 offen lds
    s_add_u32 m0, s55, 2048
    s_add_u32 s51, s53, 15360
    buffer_load_dwordx4 v131, s[12:15], s51 offen lds
    s_add_u32 m0, s55, 8192
    s_add_u32 s51, s53, 0
    s_nop 0
    buffer_load_dwordx4 v139, s[12:15], s51 offen lds
    s_add_u32 m0, s55, 10240
    s_add_u32 s51, s53, 15360
    buffer_load_dwordx4 v139, s[12:15], s51 offen lds
    s_add_u32 s53, s53, 122880
    s_add_u32 m0, s55, 16384
    s_add_u32 s51, s53, 0
    s_nop 0
    buffer_load_dwordx4 v131, s[12:15], s51 offen lds
    s_add_u32 m0, s55, 18432
    s_add_u32 s51, s53, 15360
    buffer_load_dwordx4 v131, s[12:15], s51 offen lds
    s_add_u32 m0, s55, 24576
    s_add_u32 s51, s53, 0
    s_nop 0
    buffer_load_dwordx4 v139, s[12:15], s51 offen lds
    s_add_u32 m0, s55, 26624
    s_add_u32 s51, s53, 15360
    buffer_load_dwordx4 v139, s[12:15], s51 offen lds
    s_add_u32 s53, s53, 122880
    s_waitcnt lgkmcnt(0)
    s_mul_i32 s60, s60, 1664525
    s_add_u32 s60, s60, 1013904223
    s_waitcnt vmcnt(4)
    s_barrier
    s_add_u32 m0, s55, 32768
    s_add_u32 s51, s53, 0
    buffer_load_dwordx4 v131, s[12:15], s51 offen lds
    s_add_u32 m0, s55, 34816
    s_add_u32 s51, s53, 15360
    buffer_load_dwordx4 v131, s[12:15], s51 offen lds
    s_add_u32 m0, s55, 40960
    s_add_u32 s51, s53, 0
    s_nop 0
    buffer_load_dwordx4 v139, s[12:15], s51 offen lds
    s_add_u32 m0, s55, 43008
    s_add_u32 s51, s53, 15360
    buffer_load_dwordx4 v139, s[12:15], s51 offen lds
    s_add_u32 s53, s53, 122880
    s_add_u32 m0, s54, 16384
    s_mov_b64 exec, s[56:57]
    buffer_load_dwordx4 v148, s[8:11], s52 offen lds
    s_mov_b64 exec, -1
    s_add_u32 m0, s54, 20480
    s_nop 0
    buffer_load_dwordx4 v149, s[8:11], s52 offen lds
    s_add_u32 m0, s54, 24576
    s_nop 0
    buffer_load_dwordx4 v150, s[8:11], s52 offen lds
    s_add_u32 m0, s54, 28672
    s_nop 0
    s_nop 0
    buffer_load_dwordx4 v151, s[8:11], s52 offen lds
    s_add_u32 s52, s52, 128
    s_add_u32 m0, s55, 49152
    s_add_u32 s51, s53, 0
    s_nop 0
    buffer_load_dwordx4 v131, s[12:15], s51 offen lds
    s_add_u32 m0, s55, 51200
    s_add_u32 s51, s53, 15360
    buffer_load_dwordx4 v131, s[12:15], s51 offen lds
    s_add_u32 m0, s55, 57344
    s_add_u32 s51, s53, 0
    s_nop 0
    buffer_load_dwordx4 v139, s[12:15], s51 offen lds
    s_add_u32 m0, s55, 59392
    s_add_u32 s51, s53, 15360
    buffer_load_dwordx4 v139, s[12:15], s51 offen lds
    s_add_u32 s53, s53, 122880
    s_mov_b32 s50, 0
P1L_loop:
    s_waitcnt vmcnt(12)
    s_barrier
    s_add_u32 m0, s55, 0
    s_add_u32 s51, s53, 0
    s_nop 0
    buffer_load_dwordx4 v131, s[12:15], s51 offen lds
    s_add_u32 m0, s55, 2048
    s_add_u32 s51, s53, 15360
    buffer_load_dwordx4 v131, s[12:15], s51 offen lds
    s_add_u32 m0, s55, 8192
    s_add_u32 s51, s53, 0
    s_nop 0
    buffer_load_dwordx4 v139, s[12:15], s51 offen lds
    s_add_u32 m0, s55, 10240
    s_add_u32 s51, s53, 15360
    buffer_load_dwordx4 v139, s[12:15], s51 offen lds
    s_add_u32 s53, s53, 122880
    s_waitcnt vmcnt(8)
    s_barrier
    s_add_u32 m0, s54, 0
    s_mov_b64 exec, s[56:57]
    buffer_load_dwordx4 v148, s[8:11], s52 offen lds
    s_mov_b64 exec, -1
    s_add_u32 m0, s54, 4096
    s_nop 0
    buffer_load_dwordx4 v149, s[8:11], s52 offen lds
    s_add_u32 m0, s54, 8192
    s_nop 0
    buffer_load_dwordx4 v150, s[8:11], s52 offen lds
    s_add_u32 m0, s54, 12288
    s_nop 0
    buffer_load_dwordx4 v151, s[8:11], s52 offen lds
    s_add_u32 s52, s52, 128
    s_add_u32 m0, s55, 16384
    s_add_u32 s51, s53, 0
    s_nop 0
    buffer_load_dwordx4 v131, s[12:15], s51 offen lds
    s_add_u32 m0, s55, 18432
    s_add_u32 s51, s53, 15360
    buffer_load_dwordx4 v131, s[12:15], s51 offen lds
    s_add_u32 m0, s55, 24576
    s_add_u32 s51, s53, 0
    s_nop 0
    buffer_load_dwordx4 v139, s[12:15], s51 offen lds
    s_add_u32 m0, s55, 26624
    s_add_u32 s51, s53, 15360
    buffer_load_dwordx4 v139, s[12:15], s51 offen lds
    s_add_u32 s53, s53, 122880
    s_waitcnt vmcnt(12)
    s_barrier
    s_add_u32 m0, s55, 32768
    s_add_u32 s51, s53, 0
    s_nop 0
    buffer_load_dwordx4 v131, s[12:15], s51 offen lds
    s_add_u32 m0, s55, 34816
    s_add_u32 s51, s53, 15360
    buffer_load_dwordx4 v131, s[12:15], s51 offen lds
    s_add_u32 m0, s55, 40960
    s_add_u32 s51, s53, 0
    s_nop 0
    buffer_load_dwordx4 v139, s[12:15], s51 offen lds
    s_add_u32 m0, s55, 43008
    s_add_u32 s51, s53, 15360
    buffer_load_dwordx4 v139, s[12:15], s51 offen lds
    s_add_u32 s53, s53, 122880
    s_waitcnt vmcnt(8)
    s_barrier
    s_add_u32 m0, s54, 16384
    s_mov_b64 exec, s[56:57]
    buffer_load_dwordx4 v148, s[8:11], s52 offen lds
    s_mov_b64 exec, -1
    s_add_u32 m0, s54, 20480
    s_nop 0
    buffer_load_dwordx4 v149, s[8:11], s52 offen lds
    s_add_u32 m0, s54, 24576
    s_nop 0
    buffer_load_dwordx4 v150, s[8:11], s52 offen lds
    s_add_u32 m0, s54, 28672
    s_nop 0
    s_nop 0
    buffer_load_dwordx4 v151, s[8:11], s52 offen lds
    s_add_u32 s52, s52, 128
    s_add_u32 m0, s55, 49152
    s_add_u32 s51, s53, 0
    s_nop 0
    buffer_load_dwordx4 v131, s[12:15], s51 offen lds
    s_add_u32 m0, s55, 51200
    s_add_u32 s51, s53, 15360
    buffer_load_dwordx4 v131, s[12:15], s51 offen lds
    s_add_u32 m0, s55, 57344
    s_add_u32 s51, s53, 0
    s_nop 0
    buffer_load_dwordx4 v139, s[12:15], s51 offen lds
    s_add_u32 m0, s55, 59392
    s_add_u32 s51, s53, 15360
    buffer_load_dwordx4 v139, s[12:15], s51 offen lds
    s_add_u32 s53, s53, 122880
    s_add_u32 s50, s50, 1
    s_cmp_lt_u32 s50, 4
    s_cbranch_scc1 P1L_loop
    s_waitcnt vmcnt(12)
    s_barrier
    s_mov_b32 m0, 144384
    s_nop 0
    buffer_load_dwordx4 v132, s[16:19], 0 offen sc1 lds
    s_add_u32 m0, s58, 98304
    s_add_u32 s48, s30, 40960
    buffer_load_dwordx4 v133, s[20:23], s48 offen lds
    s_add_u32 m0, s58, 102400
    s_add_u32 s48, s30, 143360
    buffer_load_dwordx4 v133, s[20:23], s48 offen lds
    s_waitcnt vmcnt(7)
    s_barrier
    s_add_u32 m0, s58, 106496
    s_add_u32 s48, s30, 61440
    buffer_load_dwordx4 v133, s[20:23], s48 offen lds
    s_add_u32 m0, s58, 110592
    s_add_u32 s48, s30, 163840
    buffer_load_dwordx4 v133, s[20:23], s48 offen lds
    s_add_u32 m0, s58, 114688
    s_add_u32 s48, s30, 81920
    buffer_load_dwordx4 v133, s[20:23], s48 offen lds
    s_add_u32 m0, s58, 118784
    s_add_u32 s48, s30, 184320
    buffer_load_dwordx4 v133, s[20:23], s48 offen lds
    s_waitcnt vmcnt(7)
    s_barrier
    s_add_u32 s48, s31, 0
    s_nop 0
    buffer_load_dwordx4 v[64:67], v133, s[20:23], s48 offen
    s_add_u32 s48, s31, 102400
    buffer_load_dwordx4 v[68:71], v133, s[20:23], s48 offen
    s_add_u32 s48, s31, 20480
    buffer_load_dwordx4 v[72:75], v133, s[20:23], s48 offen
    s_add_u32 s48, s31, 122880
    buffer_load_dwordx4 v[76:79], v133, s[20:23], s48 offen
    s_waitcnt vmcnt(10)
    s_barrier
    s_cmp_lg_u32 s3, 0
    s_cbranch_scc1 P1L_noseen
    v_mov_b32 v50, s60
    s_lshl_b32 s48, s2, 2
    s_add_u32 s48, s48, 0x1a000
    s_mov_b64 exec, 1
    buffer_store_dword v50, off, s[16:19], s48 sc1
    s_mov_b64 exec, -1
P1L_noseen:
    s_lshl_b32 s48, s3, 10
    s_add_u32 m0, s48, 145408
    s_nop 0
    buffer_load_dwordx4 v134, s[8:11], 0 offen lds
    s_add_u32 m0, s48, 149504
    s_nop 0
    buffer_load_dwordx4 v135, s[8:11], 0 offen lds
    s_add_u32 m0, s48, 153600
    s_nop 0
    buffer_load_dwordx4 v136, s[8:11], 0 offen lds
    s_mov_b32 m0, 157696
    s_mov_b64 exec, 0xffffff
    buffer_load_dwordx4 v137, s[16:19], 0 offen sc1 lds
    s_mov_b32 m0, 158080
    s_mov_b64 exec, 1
    s_mov_b32 s48, 0x10000
    buffer_load_dwordx4 off, s[16:19], s48 sc1 lds
    s_mov_b64 exec, -1
    s_add_u32 m0, s58, 0
    s_add_u32 s48, s28, 0
    buffer_load_dwordx4 v133, s[20:23], s48 offen lds
    s_add_u32 m0, s58, 4096
    s_add_u32 s48, s28, 102400
    buffer_load_dwordx4 v133, s[20:23], s48 offen lds
    s_add_u32 m0, s58, 8192
    s_add_u32 s48, s28, 20480
    buffer_load_dwordx4 v133, s[20:23], s48 offen lds
    s_add_u32 m0, s58, 12288
    s_add_u32 s48, s28, 122880
    buffer_load_dwordx4 v133, s[20:23], s48 offen lds
    s_add_u32 m0, s58, 16384
    s_add_u32 s48, s28, 40960
    buffer_load_dwordx4 v133, s[20:23], s48 offen lds
    s_add_u32 m0, s58, 20480
    s_add_u32 s48, s28, 143360
    buffer_load_dwordx4 v133, s[20:23], s48 offen lds
    s_add_u32 m0, s58, 24576
    s_add_u32 s48, s28, 61440
    buffer_load_dwordx4 v133, s[20:23], s48 offen lds
    s_add_u32 m0, s58, 28672
    s_add_u32 s48, s28, 163840
    buffer_load_dwordx4 v133, s[20:23], s48 offen lds
    s_add_u32 m0, s58, 32768
    s_add_u32 s48, s28, 81920
    buffer_load_dwordx4 v133, s[20:23], s48 offen lds
    s_add_u32 m0, s58, 36864
    s_add_u32 s48, s28, 184320
    buffer_load_dwordx4 v133, s[20:23], s48 offen lds
    s_add_u32 m0, s58, 40960
    s_add_u32 s48, s29, 0
    s_nop 0
    buffer_load_dwordx4 v133, s[20:23], s48 offen lds
    s_add_u32 m0, s58, 45056
    s_add_u32 s48, s29, 102400
    buffer_load_dwordx4 v133, s[20:23], s48 offen lds
    s_add_u32 m0, s58, 49152
    s_add_u32 s48, s29, 20480
    buffer_load_dwordx4 v133, s[20:23], s48 offen lds
    s_add_u32 m0, s58, 53248
    s_add_u32 s48, s29, 122880
    buffer_load_dwordx4 v133, s[20:23], s48 offen lds
    s_add_u32 m0, s58, 57344
    s_add_u32 s48, s29, 40960
    buffer_load_dwordx4 v133, s[20:23], s48 offen lds
    s_add_u32 m0, s58, 61440
    s_add_u32 s48, s29, 143360
    buffer_load_dwordx4 v133, s[20:23], s48 offen lds
    s_add_u32 m0, s58, 65536
    s_add_u32 s48, s29, 61440
    buffer_load_dwordx4 v133, s[20:23], s48 offen lds
    s_add_u32 m0, s58, 69632
    s_add_u32 s48, s29, 163840
    buffer_load_dwordx4 v133, s[20:23], s48 offen lds
    s_add_u32 m0, s58, 73728
    s_add_u32 s48, s29, 81920
    buffer_load_dwordx4 v133, s[20:23], s48 offen lds
    s_add_u32 m0, s58, 77824
    s_add_u32 s48, s29, 184320
    buffer_load_dwordx4 v133, s[20:23], s48 offen lds
    s_add_u32 m0, s58, 81920
    s_add_u32 s48, s30, 0
    s_nop 0
    buffer_load_dwordx4 v133, s[20:23], s48 offen lds
    s_add_u32 m0, s58, 86016
    s_add_u32 s48, s30, 102400
    buffer_load_dwordx4 v133, s[20:23], s48 offen lds
    s_add_u32 m0, s58, 90112
    s_add_u32 s48, s30, 20480
    buffer_load_dwordx4 v133, s[20:23], s48 offen lds
    s_add_u32 m0, s58, 94208
    s_add_u32 s48, s30, 122880
    buffer_load_dwordx4 v133, s[20:23], s48 offen lds
    s_add_u32 s48, s31, 40960
    buffer_load_dwordx4 v[80:83], v133, s[20:23], s48 offen
    s_add_u32 s48, s31, 143360
    buffer_load_dwordx4 v[84:87], v133, s[20:23], s48 offen
    s_add_u32 s48, s31, 61440
    buffer_load_dwordx4 v[88:91], v133, s[20:23], s48 offen
    s_add_u32 s48, s31, 163840
    buffer_load_dwordx4 v[92:95], v133, s[20:23], s48 offen
    s_add_u32 s48, s31, 81920
    buffer_load_dwordx4 v[96:99], v133, s[20:23], s48 offen
    s_add_u32 s48, s31, 184320
    buffer_load_dwordx4 v[100:103], v133, s[20:23], s48 offen
    s_waitcnt vmcnt(30)
    s_barrier
    s_branch K_p2L
K_C:
    s_sub_u32 s49, s3, 4
    v_mov_b32 v128, 0x3f803f80
    v_mov_b32 v129, 0x3f803f80
    v_mov_b32 v130, 0x3f803f80
    v_mov_b32 v131, 0x3f803f80
    s_cmp_ge_u32 s49, 2
    s_cbranch_scc1 P1C_noones
    s_mul_i32 s48, s49, 16384
    s_add_u32 s48, s48, 65536
    v_lshl_add_u32 v16, v2, 4, s48
    s_mov_b64 exec, 0xff
    ds_write_b128 v16, v[128:131]
    s_mov_b64 exec, -1
P1C_noones:
    v_mov_b32 v16, 158112
    v_mov_b32 v17, 0
    ds_write_b32 v16, v17
    v_and_b32 v20, 1, v3
    v_lshl_add_u32 v20, v20, 2, v4
    v_lshlrev_b32 v20, 2, v20
    v_lshl_add_u32 v21, v3, 3, v4
    v_lshlrev_b32 v21, 9, v21
    s_mul_i32 s48, s49, 5
    v_add_u32 v20, s48, v20
    v_mov_b32 v22, v5
    v_add_u32 v23, 22, v5
    v_add_u32 v24, 44, v5
    v_cmp_eq_u32 vcc, 0, v5
    s_nop 1
    v_cndmask_b32 v24, v24, 4, vcc
    v_lshlrev_b32 v25, 2, v5
    v_add_u32 v25, 40, v25
    v_cndmask_b32 v25, v25, 26, vcc
    s_and_b32 s57, s49, 1
    s_sub_u32 s57, 21, s57
    s_sub_u32 s57, s57, s48
    v_mov_b32 v26, s57
    v_cmp_eq_u32 vcc, 3, v5
    s_nop 1
    v_cndmask_b32 v25, v25, v26, vcc
    s_and_b32 s57, s44, 3
    s_lshl_b32 s57, s57, 2
    s_sub_u32 s57, 16, s57
    v_mov_b32 v29, 8192
    v_add_u32 v26, v22, v20
    v_and_b32 v26, 63, v26
    v_lshl_add_u32 v216, v26, 3, v21
    v_add_u32 v27, s48, v22
    v_mul_u32_u24 v28, 47, v27
    v_lshrrev_b32 v28, 10, v28
    v_mul_u32_u24 v28, 22, v28
    v_sub_u32 v27, v27, v28
    v_cmp_le_u32 vcc, s57, v27
    s_nop 1
    v_cndmask_b32 v28, 0, v29, vcc
    v_xor_b32 v216, v216, v28
    v_add_u32 v26, v23, v20
    v_and_b32 v26, 63, v26
    v_lshl_add_u32 v217, v26, 3, v21
    v_add_u32 v27, s48, v23
    v_mul_u32_u24 v28, 47, v27
    v_lshrrev_b32 v28, 10, v28
    v_mul_u32_u24 v28, 22, v28
    v_sub_u32 v27, v27, v28
    v_cmp_le_u32 vcc, s57, v27
    s_nop 1
    v_cndmask_b32 v28, 0, v29, vcc
    v_xor_b32 v217, v217, v28
    v_add_u32 v26, v24, v20
    v_and_b32 v26, 63, v26
    v_lshl_add_u32 v218, v26, 3, v21
    v_add_u32 v27, s48, v24
    v_mul_u32_u24 v28, 47, v27
    v_lshrrev_b32 v28, 10, v28
    v_mul_u32_u24 v28, 22, v28
    v_sub_u32 v27, v27, v28
    v_cmp_le_u32 vcc, s57, v27
    s_nop 1
    v_cndmask_b32 v28, 0, v29, vcc
    v_xor_b32 v218, v218, v28
    v_add_u32 v26, v25, v20
    v_and_b32 v26, 63, v26
    v_lshl_add_u32 v219, v26, 3, v21
    v_add_u32 v27, s48, v25
    v_mul_u32_u24 v28, 47, v27
    v_lshrrev_b32 v28, 10, v28
    v_mul_u32_u24 v28, 22, v28
    v_sub_u32 v27, v27, v28
    v_cmp_le_u32 vcc, s57, v27
    s_nop 1
    v_cndmask_b32 v28, 0, v29, vcc
    v_xor_b32 v219, v219, v28
    v_lshrrev_b32 v20, 1, v6
    v_xor_b32 v20, v20, v3
    v_lshlrev_b32_e64 v20, 4, v20
    v_lshl_add_u32 v20, v6, 7, v20
    v_add_u32 v220, 65536, v20
    v_xor_b32 v221, 64, v220
    s_waitcnt lgkmcnt(0)
    s_add_u32 s48, s84, 0x18000
    s_addc_u32 s49, s85, 0
    s_load_dword s60, s[48:49], 0
    s_mov_b32 s8, s64
    s_and_b32 s9, s65, 0xffff
    s_mov_b32 s10, 0x280000
    s_mov_b32 s11, 0x20000
    s_mov_b32 s12, s66
    s_nop 0
    s_and_b32 s13, s67, 0xffff
    s_mov_b32 s14, 0x258000
    s_mov_b32 s15, 0x20000
    s_mov_b32 s16, s84
    s_nop 0
    s_and_b32 s17, s85, 0xffff
    s_mov_b32 s18, 0x10000000
    s_mov_b32 s19, 0x20000
    s_mov_b32 s24, s80
    s_nop 0
    s_and_b32 s25, s81, 0xffff
    s_mov_b32 s26, 0x280000
    s_mov_b32 s27, 0x20000
    v_lshlrev_b32 v20, 2, v3
    v_sub_u32 v20, v6, v20
    v_mov_b32 v21, 0xf149f2ca
    s_cmp_eq_u32 s46, 0
    s_cselect_b32 s54, 0, -1
    v_mov_b32 v22, 0xffff
    v_mov_b32 v23, s7
    v_subrev_u32 v24, 0, v20
    v_cmp_gt_u32 vcc, 8, v24
    s_nop 1
    v_cndmask_b32 v224, v21, 0, vcc
    v_cndmask_b32 v222, 0, v22, vcc
    s_and_b32 vcc_lo, vcc_lo, s54
    v_cndmask_b32 v232, v21, 0, vcc
    v_cmp_gt_i32 vcc, -8, v24
    s_nop 1
    v_cndmask_b32 v228, v21, 0, vcc
    v_subrev_u32 v24, 1, v20
    v_cmp_gt_u32 vcc, 8, v24
    s_nop 1
    v_cndmask_b32 v225, v21, 0, vcc
    v_cndmask_b32 v25, 0, v23, vcc
    v_or_b32 v222, v222, v25
    s_and_b32 vcc_lo, vcc_lo, s54
    v_cndmask_b32 v233, v21, 0, vcc
    v_cmp_gt_i32 vcc, -8, v24
    s_nop 1
    v_cndmask_b32 v229, v21, 0, vcc
    v_subrev_u32 v24, 2, v20
    v_cmp_gt_u32 vcc, 8, v24
    s_nop 1
    v_cndmask_b32 v226, v21, 0, vcc
    v_cndmask_b32 v223, 0, v22, vcc
    s_and_b32 vcc_lo, vcc_lo, s54
    v_cndmask_b32 v234, v21, 0, vcc
    v_cmp_gt_i32 vcc, -8, v24
    s_nop 1
    v_cndmask_b32 v230, v21, 0, vcc
    v_subrev_u32 v24, 3, v20
    v_cmp_gt_u32 vcc, 8, v24
    s_nop 1
    v_cndmask_b32 v227, v21, 0, vcc
    v_cndmask_b32 v25, 0, v23, vcc
    v_or_b32 v223, v223, v25
    s_and_b32 vcc_lo, vcc_lo, s54
    v_cndmask_b32 v235, v21, 0, vcc
    v_cmp_gt_i32 vcc, -8, v24
    s_nop 1
    v_cndmask_b32 v231, v21, 0, vcc
    s_sub_u32 s57, s3, 4
    s_mul_i32 s55, s57, 5376
    s_add_u32 s55, s55, 122880
    v_lshlrev_b32 v20, 3, v4
    v_add_u32 v20, 4, v20
    v_cmp_eq_u32 vcc, 0, v4
    s_nop 1
    v_cndmask_b32 v20, v20, 8, vcc
    v_add_u32 v20, v20, v5
    v_add_u32 v21, 16, v5
    v_cndmask_b32 v21, 63, v21, vcc
    v_and_b32 v22, 1, v5
    v_lshlrev_b32 v22, 4, v22
    v_mov_b32 v23, 0x3f80
    v_lshlrev_b32 v22, v22, v23
    v_lshrrev_b32 v20, 1, v20
    v_lshl_add_u32 v23, v3, 2, 0
    v_cmp_eq_u32 vcc, v23, v20
    s_nop 1
    v_cndmask_b32 v236, 0, v22, vcc
    v_lshl_add_u32 v23, v3, 2, 1
    v_cmp_eq_u32 vcc, v23, v20
    s_nop 1
    v_cndmask_b32 v237, 0, v22, vcc
    v_lshl_add_u32 v23, v3, 2, 2
    v_cmp_eq_u32 vcc, v23, v20
    s_nop 1
    v_cndmask_b32 v238, 0, v22, vcc
    v_lshl_add_u32 v23, v3, 2, 3
    v_cmp_eq_u32 vcc, v23, v20
    s_nop 1
    v_cndmask_b32 v239, 0, v22, vcc
    v_lshrrev_b32 v21, 1, v21
    v_lshl_add_u32 v23, v3, 2, 0
    v_cmp_eq_u32 vcc, v23, v21
    s_nop 1
    v_cndmask_b32 v240, 0, v22, vcc
    v_lshl_add_u32 v23, v3, 2, 1
    v_cmp_eq_u32 vcc, v23, v21
    s_nop 1
    v_cndmask_b32 v241, 0, v22, vcc
    v_lshl_add_u32 v23, v3, 2, 2
    v_cmp_eq_u32 vcc, v23, v21
    s_nop 1
    v_cndmask_b32 v242, 0, v22, vcc
    v_lshl_add_u32 v23, v3, 2, 3
    v_cmp_eq_u32 vcc, v23, v21
    s_nop 1
    v_cndmask_b32 v243, 0, v22, vcc
    v_cmp_eq_u32 vcc, 0, v3
    v_mul_u32_u24 v20, 48, v6
    v_add_u32 v20, s55, v20
    v_lshl_add_u32 v244, v3, 3, v20
    v_add_u32 v245, 40, v20
    v_add_u32 v20, 32, v20
    v_cndmask_b32 v245, v245, v20, vcc
    v_lshlrev_b32_e64 v249, 3, v6
    v_add_u32 v249, 144384, v249
    v_subrev_u32 v20, 256, v0
    v_min_u32 v20, 239, v20
    v_lshlrev_b32 v248, 4, v20
    v_mul_u32_u24 v21, 205, v20
    v_lshrrev_b32 v21, 11, v21
    v_mul_u32_u24 v22, 10, v21
    v_sub_u32 v20, v20, v22
    v_lshlrev_b32 v20, 1, v20
    v_mul_u32_u24 v21, 48, v21
    v_add_u32 v21, 123264, v21
    v_mul_u32_u24 v22, 52, v20
    v_lshrrev_b32 v22, 8, v22
    v_mul_u32_u24 v22, 5336, v22
    v_lshl_add_u32 v246, v20, 3, v22
    v_add_u32 v246, v246, v21
    v_add_u32 v20, 1, v20
    v_mul_u32_u24 v22, 52, v20
    v_lshrrev_b32 v22, 8, v22
    v_mul_u32_u24 v22, 5336, v22
    v_lshl_add_u32 v247, v20, 3, v22
    v_add_u32_e64 v247, v247, v21
    s_lshl_b32 s56, s45, 10
    s_add_u32 s56, s56, s46
    s_mul_i32 s56, s56, 160
    s_mul_i32 s51, s44, 327680
    s_add_u32 s56, s56, s51
    s_add_u32 s56, s56, 0x100000
    s_add_u32 s32, s84, s56
    s_addc_u32 s33, s85, 0
    s_nop 0
    s_and_b32 s33, s33, 0xffff
    s_sub_u32 s51, 1024, s46
    s_min_u32 s51, s51, 104
    s_mul_i32 s34, s51, 160
    s_mov_b32 s35, 0x20000
    s_lshl_b32 s51, s47, 3
    s_add_u32 s44, s44, s51
    s_lshl_b32 s44, s44, 5
    s_add_u32 s44, s44, s57
    s_lshl_b32 s44, s44, 2
    s_add_u32 s44, s44, 0x60000
    s_mul_i32 s6, s4, 27
    s_add_u32 s6, s6, s5
    s_mul_i32 s61, s6, 205
    s_lshr_b32 s61, s61, 10
    s_mul_i32 s62, s61, 5
    s_sub_u32 s62, s6, s62
    s_cmp_lt_u32 s6, 215
    s_cselect_b32 s63, 1, 0
    s_cmp_lt_u32 s5, 27
    s_cselect_b32 s63, s63, 0
    s_and_b32 s40, s3, 3
    s_mul_i32 s42, s61, 48
    s_lshl_b32 s43, s62, 8
    s_lshl_b32 s6, s40, 6
    s_add_u32 s43, s43, s6
    v_and_b32_e64 v20, 1, v3
    v_lshl_add_u32 v20, v20, 2, v4
    v_lshl_add_u32 v20, v20, 2, v5
    s_lshl_b32 s51, s40, 3
    v_add_u32 v10, s51, v20
    v_add_u32 v11, 4, v10
    v_and_b32 v10, 31, v10
    v_and_b32 v11, 31, v11
    v_lshl_add_u32 v20, v3, 3, v4
    v_lshlrev_b32 v20, 8, v20
    v_lshl_add_u32 v10, v10, 3, v20
    v_lshl_add_u32 v11, v11, 3, v20
    v_add_u32 v1, s42, v6
    v_and_b32 v20, 1, v3
    v_lshlrev_b32 v20, 5, v20
    v_lshrrev_b32 v21, 1, v3
    v_lshl_add_u32 v20, v21, 4, v20
    v_add_u32 v20, s43, v20
    v_mov_b32 v23, 0x80000000
    s_movk_i32 s51, 1280
    v_add_u32 v21, 0, v1
    v_cmp_gt_u32 vcc, 2048, v21
    v_lshrrev_b32 v22, 10, v21
    v_and_b32 v21, 1023, v21
    v_lshl_add_u32 v21, v21, 1, v22
    v_mad_u32_u24 v21, v21, s51, v20
    v_cndmask_b32 v7, v23, v21, vcc
    v_add_u32 v21, 16, v1
    v_cmp_gt_u32 vcc, 2048, v21
    v_lshrrev_b32_e64 v22, 10, v21
    v_and_b32 v21, 1023, v21
    v_lshl_add_u32 v21, v21, 1, v22
    v_mad_u32_u24 v21, v21, s51, v20
    v_cndmask_b32 v8, v23, v21, vcc
    v_add_u32 v21, 32, v1
    v_cmp_gt_u32 vcc, 2048, v21
    v_lshrrev_b32_e64 v22, 10, v21
    v_and_b32 v21, 1023, v21
    v_lshl_add_u32 v21, v21, 1, v22
    v_mad_u32_u24 v21, v21, s51, v20
    v_cndmask_b32 v9, v23, v21, vcc
    v_lshrrev_b32 v20, 1, v3
    v_mul_u32_u24 v20, 2560, v20
    v_mul_u32_u24 v21, 160, v6
    v_add_u32 v20, v20, v21
    v_and_b32 v21, 1, v3
    v_lshl_add_u32 v4, v21, 4, v20
    s_mov_b32 s58, 0x3ea52b5c
    s_waitcnt lgkmcnt(0)
    s_mul_i32 s60, s60, 1664525
    s_add_u32 s60, s60, 1013904223
    s_barrier
    ds_read_b64_tr_b16 v[128:129], v216 offset:0
    ds_read_b64_tr_b16 v[130:131], v216 offset:2048
    ds_read_b64_tr_b16 v[132:133], v217 offset:0
    ds_read_b64_tr_b16 v[134:135], v217 offset:2048
    ds_read_b64_tr_b16 v[136:137], v218 offset:0
    ds_read_b64_tr_b16 v[138:139], v218 offset:2048
    ds_read_b64_tr_b16 v[140:141], v219 offset:0
    ds_read_b64_tr_b16 v[142:143], v219 offset:2048
    ds_read_b128 v[144:147], v220 offset:0
    ds_read_b128 v[148:151], v220 offset:2048
    ds_read_b128 v[152:155], v220 offset:4096
    ds_read_b128 v[156:159], v220 offset:6144
    ds_read_b128 v[160:163], v220 offset:8192
    ds_read_b128 v[164:167], v220 offset:10240
    ds_read_b128 v[168:171], v220 offset:12288
    s_waitcnt lgkmcnt(0)
    s_barrier
    v_mfma_f32_16x16x32_bf16 v[16:19], v[128:131], v[144:147], 0
    ds_read_b64_tr_b16 v[200:201], v216 offset:16384
    v_mfma_f32_16x16x32_bf16 v[32:35], v[128:131], v[148:151], 0
    ds_read_b64_tr_b16 v[202:203], v216 offset:18432
    v_mfma_f32_16x16x32_bf16 v[48:51], v[128:131], v[152:155], 0
    ds_read_b64_tr_b16 v[204:205], v217 offset:16384
    v_mfma_f32_16x16x32_bf16 v[64:67], v[128:131], v[156:159], 0
    ds_read_b64_tr_b16 v[206:207], v217 offset:18432
    v_mfma_f32_16x16x32_bf16 v[80:83], v[128:131], v[160:163], 0
    ds_read_b64_tr_b16 v[208:209], v218 offset:16384
    v_mfma_f32_16x16x32_bf16 v[96:99], v[128:131], v[164:167], 0
    ds_read_b64_tr_b16 v[210:211], v218 offset:18432
    v_mfma_f32_16x16x32_bf16 v[112:115], v[128:131], v[168:171], 0
    ds_read_b64_tr_b16 v[212:213], v219 offset:16384
    v_mfma_f32_16x16x32_bf16 v[116:119], v[132:135], v[168:171], 0
    ds_read_b64_tr_b16 v[214:215], v219 offset:18432
    v_mfma_f32_16x16x32_bf16 v[100:103], v[132:135], v[164:167], 0
    ds_read_b128 v[172:175], v221 offset:0
    v_mfma_f32_16x16x32_bf16 v[84:87], v[132:135], v[160:163], 0
    ds_read_b128 v[176:179], v221 offset:2048
    v_mfma_f32_16x16x32_bf16 v[68:71], v[132:135], v[156:159], 0
    ds_read_b128 v[180:183], v221 offset:4096
    v_mfma_f32_16x16x32_bf16 v[52:55], v[132:135], v[152:155], 0
    ds_read_b128 v[184:187], v221 offset:6144
    v_mfma_f32_16x16x32_bf16 v[36:39], v[132:135], v[148:151], 0
    ds_read_b128 v[188:191], v221 offset:8192
    v_mfma_f32_16x16x32_bf16 v[20:23], v[132:135], v[144:147], 0
    ds_read_b128 v[192:195], v221 offset:10240
    v_mfma_f32_16x16x32_bf16 v[24:27], v[136:139], v[144:147], 0
    ds_read_b128 v[196:199], v221 offset:12288
    v_mfma_f32_16x16x32_bf16 v[40:43], v[136:139], v[148:151], 0
    v_mfma_f32_16x16x32_bf16 v[56:59], v[136:139], v[152:155], 0
    v_mfma_f32_16x16x32_bf16 v[72:75], v[136:139], v[156:159], 0
    v_mfma_f32_16x16x32_bf16 v[88:91], v[136:139], v[160:163], 0
    v_mfma_f32_16x16x32_bf16 v[104:107], v[136:139], v[164:167], 0
    v_mfma_f32_16x16x32_bf16 v[120:123], v[136:139], v[168:171], 0
    v_mfma_f32_16x16x32_bf16 v[124:127], v[140:143], v[168:171], 0
    v_mfma_f32_16x16x32_bf16 v[108:111], v[140:143], v[164:167], 0
    v_mfma_f32_16x16x32_bf16 v[92:95], v[140:143], v[160:163], 0
    v_mfma_f32_16x16x32_bf16 v[76:79], v[140:143], v[156:159], 0
    v_mfma_f32_16x16x32_bf16 v[60:63], v[140:143], v[152:155], 0
    v_mfma_f32_16x16x32_bf16 v[44:47], v[140:143], v[148:151], 0
    v_mfma_f32_16x16x32_bf16 v[28:31], v[140:143], v[144:147], 0
    s_waitcnt lgkmcnt(0)
    s_mov_b32 s48, 0
    s_branch P1C_in
P1C_loop:
    s_barrier
    v_mfma_f32_16x16x32_bf16 v[16:19], v[128:131], v[144:147], v[16:19]
    ds_read_b64_tr_b16 v[200:201], v216 offset:16384
    v_mfma_f32_16x16x32_bf16 v[32:35], v[128:131], v[148:151], v[32:35]
    ds_read_b64_tr_b16 v[202:203], v216 offset:18432
    v_mfma_f32_16x16x32_bf16 v[48:51], v[128:131], v[152:155], v[48:51]
    ds_read_b64_tr_b16 v[204:205], v217 offset:16384
    v_mfma_f32_16x16x32_bf16 v[64:67], v[128:131], v[156:159], v[64:67]
    ds_read_b64_tr_b16 v[206:207], v217 offset:18432
    v_mfma_f32_16x16x32_bf16 v[80:83], v[128:131], v[160:163], v[80:83]
    ds_read_b64_tr_b16 v[208:209], v218 offset:16384
    v_mfma_f32_16x16x32_bf16 v[96:99], v[128:131], v[164:167], v[96:99]
    ds_read_b64_tr_b16 v[210:211], v218 offset:18432
    v_mfma_f32_16x16x32_bf16 v[112:115], v[128:131], v[168:171], v[112:115]
    ds_read_b64_tr_b16 v[212:213], v219 offset:16384
    v_mfma_f32_16x16x32_bf16 v[116:119], v[132:135], v[168:171], v[116:119]
    ds_read_b64_tr_b16 v[214:215], v219 offset:18432
    v_mfma_f32_16x16x32_bf16 v[100:103], v[132:135], v[164:167], v[100:103]
    ds_read_b128 v[172:175], v221 offset:0
    v_mfma_f32_16x16x32_bf16 v[84:87], v[132:135], v[160:163], v[84:87]
    ds_read_b128 v[176:179], v221 offset:2048
    v_mfma_f32_16x16x32_bf16 v[68:71], v[132:135], v[156:159], v[68:71]
    ds_read_b128 v[180:183], v221 offset:4096
    v_mfma_f32_16x16x32_bf16 v[52:55], v[132:135], v[152:155], v[52:55]
    ds_read_b128 v[184:187], v221 offset:6144
    v_mfma_f32_16x16x32_bf16 v[36:39], v[132:135], v[148:151], v[36:39]
    ds_read_b128 v[188:191], v221 offset:8192
    v_mfma_f32_16x16x32_bf16 v[20:23], v[132:135], v[144:147], v[20:23]
    ds_read_b128 v[192:195], v221 offset:10240
    v_mfma_f32_16x16x32_bf16 v[24:27], v[136:139], v[144:147], v[24:27]
    ds_read_b128 v[196:199], v221 offset:12288
    v_mfma_f32_16x16x32_bf16 v[40:43], v[136:139], v[148:151], v[40:43]
    v_mfma_f32_16x16x32_bf16 v[56:59], v[136:139], v[152:155], v[56:59]
    v_mfma_f32_16x16x32_bf16 v[72:75], v[136:139], v[156:159], v[72:75]
    v_mfma_f32_16x16x32_bf16 v[88:91], v[136:139], v[160:163], v[88:91]
    v_mfma_f32_16x16x32_bf16 v[104:107], v[136:139], v[164:167], v[104:107]
    v_mfma_f32_16x16x32_bf16 v[120:123], v[136:139], v[168:171], v[120:123]
    v_mfma_f32_16x16x32_bf16 v[124:127], v[140:143], v[168:171], v[124:127]
    v_mfma_f32_16x16x32_bf16 v[108:111], v[140:143], v[164:167], v[108:111]
    v_mfma_f32_16x16x32_bf16 v[92:95], v[140:143], v[160:163], v[92:95]
    v_mfma_f32_16x16x32_bf16 v[76:79], v[140:143], v[156:159], v[76:79]
    v_mfma_f32_16x16x32_bf16 v[60:63], v[140:143], v[152:155], v[60:63]
    v_mfma_f32_16x16x32_bf16 v[44:47], v[140:143], v[148:151], v[44:47]
    v_mfma_f32_16x16x32_bf16 v[28:31], v[140:143], v[144:147], v[28:31]
    s_waitcnt lgkmcnt(0)
P1C_in:
    s_barrier
    v_mfma_f32_16x16x32_bf16 v[16:19], v[200:203], v[172:175], v[16:19]
    ds_read_b64_tr_b16 v[128:129], v216 offset:32768
    v_mfma_f32_16x16x32_bf16 v[32:35], v[200:203], v[176:179], v[32:35]
    ds_read_b64_tr_b16 v[130:131], v216 offset:34816
    v_mfma_f32_16x16x32_bf16 v[48:51], v[200:203], v[180:183], v[48:51]
    ds_read_b64_tr_b16 v[132:133], v217 offset:32768
    v_mfma_f32_16x16x32_bf16 v[64:67], v[200:203], v[184:187], v[64:67]
    ds_read_b64_tr_b16 v[134:135], v217 offset:34816
    v_mfma_f32_16x16x32_bf16 v[80:83], v[200:203], v[188:191], v[80:83]
    ds_read_b64_tr_b16 v[136:137], v218 offset:32768
    v_mfma_f32_16x16x32_bf16 v[96:99], v[200:203], v[192:195], v[96:99]
    ds_read_b64_tr_b16 v[138:139], v218 offset:34816
    v_mfma_f32_16x16x32_bf16 v[112:115], v[200:203], v[196:199], v[112:115]
    ds_read_b64_tr_b16 v[140:141], v219 offset:32768
    v_mfma_f32_16x16x32_bf16 v[116:119], v[204:207], v[196:199], v[116:119]
    ds_read_b64_tr_b16 v[142:143], v219 offset:34816
    v_mfma_f32_16x16x32_bf16 v[100:103], v[204:207], v[192:195], v[100:103]
    ds_read_b128 v[144:147], v220 offset:16384
    v_mfma_f32_16x16x32_bf16 v[84:87], v[204:207], v[188:191], v[84:87]
    ds_read_b128 v[148:151], v220 offset:18432
    v_mfma_f32_16x16x32_bf16 v[68:71], v[204:207], v[184:187], v[68:71]
    ds_read_b128 v[152:155], v220 offset:20480
    v_mfma_f32_16x16x32_bf16 v[52:55], v[204:207], v[180:183], v[52:55]
    ds_read_b128 v[156:159], v220 offset:22528
    v_mfma_f32_16x16x32_bf16 v[36:39], v[204:207], v[176:179], v[36:39]
    ds_read_b128 v[160:163], v220 offset:24576
    v_mfma_f32_16x16x32_bf16 v[20:23], v[204:207], v[172:175], v[20:23]
    ds_read_b128 v[164:167], v220 offset:26624
    v_mfma_f32_16x16x32_bf16 v[24:27], v[208:211], v[172:175], v[24:27]
    ds_read_b128 v[168:171], v220 offset:28672
    v_mfma_f32_16x16x32_bf16 v[40:43], v[208:211], v[176:179], v[40:43]
    v_mfma_f32_16x16x32_bf16 v[56:59], v[208:211], v[180:183], v[56:59]
    v_mfma_f32_16x16x32_bf16 v[72:75], v[208:211], v[184:187], v[72:75]
    v_mfma_f32_16x16x32_bf16 v[88:91], v[208:211], v[188:191], v[88:91]
    v_mfma_f32_16x16x32_bf16 v[104:107], v[208:211], v[192:195], v[104:107]
    v_mfma_f32_16x16x32_bf16 v[120:123], v[208:211], v[196:199], v[120:123]
    v_mfma_f32_16x16x32_bf16 v[124:127], v[212:215], v[196:199], v[124:127]
    v_mfma_f32_16x16x32_bf16 v[108:111], v[212:215], v[192:195], v[108:111]
    v_mfma_f32_16x16x32_bf16 v[92:95], v[212:215], v[188:191], v[92:95]
    v_mfma_f32_16x16x32_bf16 v[76:79], v[212:215], v[184:187], v[76:79]
    v_mfma_f32_16x16x32_bf16 v[60:63], v[212:215], v[180:183], v[60:63]
    v_mfma_f32_16x16x32_bf16 v[44:47], v[212:215], v[176:179], v[44:47]
    v_mfma_f32_16x16x32_bf16 v[28:31], v[212:215], v[172:175], v[28:31]
    s_waitcnt lgkmcnt(0)
    s_barrier
    v_mfma_f32_16x16x32_bf16 v[16:19], v[128:131], v[144:147], v[16:19]
    ds_read_b64_tr_b16 v[200:201], v216 offset:49152
    v_mfma_f32_16x16x32_bf16 v[32:35], v[128:131], v[148:151], v[32:35]
    ds_read_b64_tr_b16 v[202:203], v216 offset:51200
    v_mfma_f32_16x16x32_bf16 v[48:51], v[128:131], v[152:155], v[48:51]
    ds_read_b64_tr_b16 v[204:205], v217 offset:49152
    v_mfma_f32_16x16x32_bf16 v[64:67], v[128:131], v[156:159], v[64:67]
    ds_read_b64_tr_b16 v[206:207], v217 offset:51200
    v_mfma_f32_16x16x32_bf16 v[80:83], v[128:131], v[160:163], v[80:83]
    ds_read_b64_tr_b16 v[208:209], v218 offset:49152
    v_mfma_f32_16x16x32_bf16 v[96:99], v[128:131], v[164:167], v[96:99]
    ds_read_b64_tr_b16 v[210:211], v218 offset:51200
    v_mfma_f32_16x16x32_bf16 v[112:115], v[128:131], v[168:171], v[112:115]
    ds_read_b64_tr_b16 v[212:213], v219 offset:49152
    v_mfma_f32_16x16x32_bf16 v[116:119], v[132:135], v[168:171], v[116:119]
    ds_read_b64_tr_b16 v[214:215], v219 offset:51200
    v_mfma_f32_16x16x32_bf16 v[100:103], v[132:135], v[164:167], v[100:103]
    ds_read_b128 v[172:175], v221 offset:16384
    v_mfma_f32_16x16x32_bf16 v[84:87], v[132:135], v[160:163], v[84:87]
    ds_read_b128 v[176:179], v221 offset:18432
    v_mfma_f32_16x16x32_bf16 v[68:71], v[132:135], v[156:159], v[68:71]
    ds_read_b128 v[180:183], v221 offset:20480
    v_mfma_f32_16x16x32_bf16 v[52:55], v[132:135], v[152:155], v[52:55]
    ds_read_b128 v[184:187], v221 offset:22528
    v_mfma_f32_16x16x32_bf16 v[36:39], v[132:135], v[148:151], v[36:39]
    ds_read_b128 v[188:191], v221 offset:24576
    v_mfma_f32_16x16x32_bf16 v[20:23], v[132:135], v[144:147], v[20:23]
    ds_read_b128 v[192:195], v221 offset:26624
    v_mfma_f32_16x16x32_bf16 v[24:27], v[136:139], v[144:147], v[24:27]
    ds_read_b128 v[196:199], v221 offset:28672
    v_mfma_f32_16x16x32_bf16 v[40:43], v[136:139], v[148:151], v[40:43]
    v_mfma_f32_16x16x32_bf16 v[56:59], v[136:139], v[152:155], v[56:59]
    v_mfma_f32_16x16x32_bf16 v[72:75], v[136:139], v[156:159], v[72:75]
    v_mfma_f32_16x16x32_bf16 v[88:91], v[136:139], v[160:163], v[88:91]
    v_mfma_f32_16x16x32_bf16 v[104:107], v[136:139], v[164:167], v[104:107]
    v_mfma_f32_16x16x32_bf16 v[120:123], v[136:139], v[168:171], v[120:123]
    v_mfma_f32_16x16x32_bf16 v[124:127], v[140:143], v[168:171], v[124:127]
    v_mfma_f32_16x16x32_bf16 v[108:111], v[140:143], v[164:167], v[108:111]
    v_mfma_f32_16x16x32_bf16 v[92:95], v[140:143], v[160:163], v[92:95]
    v_mfma_f32_16x16x32_bf16 v[76:79], v[140:143], v[156:159], v[76:79]
    v_mfma_f32_16x16x32_bf16 v[60:63], v[140:143], v[152:155], v[60:63]
    v_mfma_f32_16x16x32_bf16 v[44:47], v[140:143], v[148:151], v[44:47]
    v_mfma_f32_16x16x32_bf16 v[28:31], v[140:143], v[144:147], v[28:31]
    s_waitcnt lgkmcnt(0)
    s_add_u32 s48, s48, 1
    s_cmp_lt_u32 s48, 4
    s_barrier
    v_mfma_f32_16x16x32_bf16 v[16:19], v[200:203], v[172:175], v[16:19]
    ds_read_b64_tr_b16 v[128:129], v216 offset:0
    v_mfma_f32_16x16x32_bf16 v[32:35], v[200:203], v[176:179], v[32:35]
    ds_read_b64_tr_b16 v[130:131], v216 offset:2048
    v_mfma_f32_16x16x32_bf16 v[48:51], v[200:203], v[180:183], v[48:51]
    ds_read_b64_tr_b16 v[132:133], v217 offset:0
    v_mfma_f32_16x16x32_bf16 v[64:67], v[200:203], v[184:187], v[64:67]
    ds_read_b64_tr_b16 v[134:135], v217 offset:2048
    v_mfma_f32_16x16x32_bf16 v[80:83], v[200:203], v[188:191], v[80:83]
    ds_read_b64_tr_b16 v[136:137], v218 offset:0
    v_mfma_f32_16x16x32_bf16 v[96:99], v[200:203], v[192:195], v[96:99]
    ds_read_b64_tr_b16 v[138:139], v218 offset:2048
    v_mfma_f32_16x16x32_bf16 v[112:115], v[200:203], v[196:199], v[112:115]
    ds_read_b64_tr_b16 v[140:141], v219 offset:0
    v_mfma_f32_16x16x32_bf16 v[116:119], v[204:207], v[196:199], v[116:119]
    ds_read_b64_tr_b16 v[142:143], v219 offset:2048
    v_mfma_f32_16x16x32_bf16 v[100:103], v[204:207], v[192:195], v[100:103]
    ds_read_b128 v[144:147], v220 offset:0
    v_mfma_f32_16x16x32_bf16 v[84:87], v[204:207], v[188:191], v[84:87]
    ds_read_b128 v[148:151], v220 offset:2048
    v_mfma_f32_16x16x32_bf16 v[68:71], v[204:207], v[184:187], v[68:71]
    ds_read_b128 v[152:155], v220 offset:4096
    v_mfma_f32_16x16x32_bf16 v[52:55], v[204:207], v[180:183], v[52:55]
    ds_read_b128 v[156:159], v220 offset:6144
    v_mfma_f32_16x16x32_bf16 v[36:39], v[204:207], v[176:179], v[36:39]
    ds_read_b128 v[160:163], v220 offset:8192
    v_mfma_f32_16x16x32_bf16 v[20:23], v[204:207], v[172:175], v[20:23]
    ds_read_b128 v[164:167], v220 offset:10240
    v_mfma_f32_16x16x32_bf16 v[24:27], v[208:211], v[172:175], v[24:27]
    ds_read_b128 v[168:171], v220 offset:12288
    v_mfma_f32_16x16x32_bf16 v[40:43], v[208:211], v[176:179], v[40:43]
    v_mfma_f32_16x16x32_bf16 v[56:59], v[208:211], v[180:183], v[56:59]
    v_mfma_f32_16x16x32_bf16 v[72:75], v[208:211], v[184:187], v[72:75]
    v_mfma_f32_16x16x32_bf16 v[88:91], v[208:211], v[188:191], v[88:91]
    v_mfma_f32_16x16x32_bf16 v[104:107], v[208:211], v[192:195], v[104:107]
    v_mfma_f32_16x16x32_bf16 v[120:123], v[208:211], v[196:199], v[120:123]
    v_mfma_f32_16x16x32_bf16 v[124:127], v[212:215], v[196:199], v[124:127]
    v_mfma_f32_16x16x32_bf16 v[108:111], v[212:215], v[192:195], v[108:111]
    v_mfma_f32_16x16x32_bf16 v[92:95], v[212:215], v[188:191], v[92:95]
    v_mfma_f32_16x16x32_bf16 v[76:79], v[212:215], v[184:187], v[76:79]
    v_mfma_f32_16x16x32_bf16 v[60:63], v[212:215], v[180:183], v[60:63]
    v_mfma_f32_16x16x32_bf16 v[44:47], v[212:215], v[176:179], v[44:47]
    v_mfma_f32_16x16x32_bf16 v[28:31], v[212:215], v[172:175], v[28:31]
    s_waitcnt lgkmcnt(0)
    s_cbranch_scc1 P1C_loop
    s_barrier
    s_nop 0
    v_mfma_f32_16x16x32_bf16 v[16:19], v[128:131], v[144:147], v[16:19]
    ds_read_b64_tr_b16 v[200:201], v216 offset:16384
    v_mfma_f32_16x16x32_bf16 v[32:35], v[128:131], v[148:151], v[32:35]
    ds_read_b64_tr_b16 v[202:203], v216 offset:18432
    v_mfma_f32_16x16x32_bf16 v[48:51], v[128:131], v[152:155], v[48:51]
    ds_read_b64_tr_b16 v[204:205], v217 offset:16384
    v_mfma_f32_16x16x32_bf16 v[64:67], v[128:131], v[156:159], v[64:67]
    ds_read_b64_tr_b16 v[206:207], v217 offset:18432
    v_mfma_f32_16x16x32_bf16 v[80:83], v[128:131], v[160:163], v[80:83]
    ds_read_b64_tr_b16 v[208:209], v218 offset:16384
    v_mfma_f32_16x16x32_bf16 v[96:99], v[128:131], v[164:167], v[96:99]
    ds_read_b64_tr_b16 v[210:211], v218 offset:18432
    v_mfma_f32_16x16x32_bf16 v[112:115], v[128:131], v[168:171], v[112:115]
    ds_read_b64_tr_b16 v[212:213], v219 offset:16384
    v_mfma_f32_16x16x32_bf16 v[116:119], v[132:135], v[168:171], v[116:119]
    ds_read_b64_tr_b16 v[214:215], v219 offset:18432
    v_mfma_f32_16x16x32_bf16 v[100:103], v[132:135], v[164:167], v[100:103]
    ds_read_b128 v[172:175], v221 offset:0
    v_mfma_f32_16x16x32_bf16 v[84:87], v[132:135], v[160:163], v[84:87]
    ds_read_b128 v[176:179], v221 offset:2048
    v_mfma_f32_16x16x32_bf16 v[68:71], v[132:135], v[156:159], v[68:71]
    ds_read_b128 v[180:183], v221 offset:4096
    v_mfma_f32_16x16x32_bf16 v[52:55], v[132:135], v[152:155], v[52:55]
    ds_read_b128 v[184:187], v221 offset:6144
    v_mfma_f32_16x16x32_bf16 v[36:39], v[132:135], v[148:151], v[36:39]
    ds_read_b128 v[188:191], v221 offset:8192
    v_mfma_f32_16x16x32_bf16 v[20:23], v[132:135], v[144:147], v[20:23]
    ds_read_b128 v[192:195], v221 offset:10240
    v_mfma_f32_16x16x32_bf16 v[24:27], v[136:139], v[144:147], v[24:27]
    ds_read_b128 v[196:199], v221 offset:12288
    v_mfma_f32_16x16x32_bf16 v[40:43], v[136:139], v[148:151], v[40:43]
    v_mfma_f32_16x16x32_bf16 v[56:59], v[136:139], v[152:155], v[56:59]
    v_mfma_f32_16x16x32_bf16 v[72:75], v[136:139], v[156:159], v[72:75]
    v_mfma_f32_16x16x32_bf16 v[88:91], v[136:139], v[160:163], v[88:91]
    v_mfma_f32_16x16x32_bf16 v[104:107], v[136:139], v[164:167], v[104:107]
    v_mfma_f32_16x16x32_bf16 v[120:123], v[136:139], v[168:171], v[120:123]
    v_mfma_f32_16x16x32_bf16 v[124:127], v[140:143], v[168:171], v[124:127]
    v_mfma_f32_16x16x32_bf16 v[108:111], v[140:143], v[164:167], v[108:111]
    v_mfma_f32_16x16x32_bf16 v[92:95], v[140:143], v[160:163], v[92:95]
    v_mfma_f32_16x16x32_bf16 v[76:79], v[140:143], v[156:159], v[76:79]
    v_mfma_f32_16x16x32_bf16 v[60:63], v[140:143], v[152:155], v[60:63]
    v_mfma_f32_16x16x32_bf16 v[44:47], v[140:143], v[148:151], v[44:47]
    v_mfma_f32_16x16x32_bf16 v[28:31], v[140:143], v[144:147], v[28:31]
    s_waitcnt lgkmcnt(0)
    s_barrier
    v_mfma_f32_16x16x32_bf16 v[16:19], v[200:203], v[172:175], v[16:19]
    ds_read_b64_tr_b16 v[128:129], v216 offset:32768
    v_mfma_f32_16x16x32_bf16 v[32:35], v[200:203], v[176:179], v[32:35]
    ds_read_b64_tr_b16 v[130:131], v216 offset:34816
    v_mfma_f32_16x16x32_bf16 v[48:51], v[200:203], v[180:183], v[48:51]
    ds_read_b64_tr_b16 v[132:133], v217 offset:32768
    v_mfma_f32_16x16x32_bf16 v[64:67], v[200:203], v[184:187], v[64:67]
    ds_read_b64_tr_b16 v[134:135], v217 offset:34816
    v_mfma_f32_16x16x32_bf16 v[80:83], v[200:203], v[188:191], v[80:83]
    ds_read_b64_tr_b16 v[136:137], v218 offset:32768
    v_mfma_f32_16x16x32_bf16 v[96:99], v[200:203], v[192:195], v[96:99]
    ds_read_b64_tr_b16 v[138:139], v218 offset:34816
    v_mfma_f32_16x16x32_bf16 v[112:115], v[200:203], v[196:199], v[112:115]
    ds_read_b64_tr_b16 v[140:141], v219 offset:32768
    v_mfma_f32_16x16x32_bf16 v[116:119], v[204:207], v[196:199], v[116:119]
    ds_read_b64_tr_b16 v[142:143], v219 offset:34816
    v_mfma_f32_16x16x32_bf16 v[100:103], v[204:207], v[192:195], v[100:103]
    ds_read_b128 v[144:147], v220 offset:16384
    v_mfma_f32_16x16x32_bf16 v[84:87], v[204:207], v[188:191], v[84:87]
    ds_read_b128 v[148:151], v220 offset:18432
    v_mfma_f32_16x16x32_bf16 v[68:71], v[204:207], v[184:187], v[68:71]
    ds_read_b128 v[152:155], v220 offset:20480
    v_mfma_f32_16x16x32_bf16 v[52:55], v[204:207], v[180:183], v[52:55]
    ds_read_b128 v[156:159], v220 offset:22528
    v_mfma_f32_16x16x32_bf16 v[36:39], v[204:207], v[176:179], v[36:39]
    ds_read_b128 v[160:163], v220 offset:24576
    v_mfma_f32_16x16x32_bf16 v[20:23], v[204:207], v[172:175], v[20:23]
    ds_read_b128 v[164:167], v220 offset:26624
    v_mfma_f32_16x16x32_bf16 v[24:27], v[208:211], v[172:175], v[24:27]
    ds_read_b128 v[168:171], v220 offset:28672
    v_mfma_f32_16x16x32_bf16 v[40:43], v[208:211], v[176:179], v[40:43]
    v_mfma_f32_16x16x32_bf16 v[56:59], v[208:211], v[180:183], v[56:59]
    v_mfma_f32_16x16x32_bf16 v[72:75], v[208:211], v[184:187], v[72:75]
    v_mfma_f32_16x16x32_bf16 v[88:91], v[208:211], v[188:191], v[88:91]
    v_mfma_f32_16x16x32_bf16 v[104:107], v[208:211], v[192:195], v[104:107]
    v_mfma_f32_16x16x32_bf16 v[120:123], v[208:211], v[196:199], v[120:123]
    v_mfma_f32_16x16x32_bf16 v[124:127], v[212:215], v[196:199], v[124:127]
    v_mfma_f32_16x16x32_bf16 v[108:111], v[212:215], v[192:195], v[108:111]
    v_mfma_f32_16x16x32_bf16 v[92:95], v[212:215], v[188:191], v[92:95]
    v_mfma_f32_16x16x32_bf16 v[76:79], v[212:215], v[184:187], v[76:79]
    v_mfma_f32_16x16x32_bf16 v[60:63], v[212:215], v[180:183], v[60:63]
    v_mfma_f32_16x16x32_bf16 v[44:47], v[212:215], v[176:179], v[44:47]
    v_mfma_f32_16x16x32_bf16 v[28:31], v[212:215], v[172:175], v[28:31]
    s_waitcnt lgkmcnt(0)
    s_barrier
    v_mfma_f32_16x16x32_bf16 v[16:19], v[128:131], v[144:147], v[16:19]
    ds_read_b64_tr_b16 v[200:201], v216 offset:49152
    v_mfma_f32_16x16x32_bf16 v[32:35], v[128:131], v[148:151], v[32:35]
    ds_read_b64_tr_b16 v[202:203], v216 offset:51200
    v_mfma_f32_16x16x32_bf16 v[48:51], v[128:131], v[152:155], v[48:51]
    ds_read_b64_tr_b16 v[204:205], v217 offset:49152
    v_mfma_f32_16x16x32_bf16 v[64:67], v[128:131], v[156:159], v[64:67]
    ds_read_b64_tr_b16 v[206:207], v217 offset:51200
    v_mfma_f32_16x16x32_bf16 v[80:83], v[128:131], v[160:163], v[80:83]
    ds_read_b64_tr_b16 v[208:209], v218 offset:49152
    v_mfma_f32_16x16x32_bf16 v[96:99], v[128:131], v[164:167], v[96:99]
    ds_read_b64_tr_b16 v[210:211], v218 offset:51200
    v_mfma_f32_16x16x32_bf16 v[112:115], v[128:131], v[168:171], v[112:115]
    ds_read_b64_tr_b16 v[212:213], v219 offset:49152
    v_mfma_f32_16x16x32_bf16 v[116:119], v[132:135], v[168:171], v[116:119]
    ds_read_b64_tr_b16 v[214:215], v219 offset:51200
    v_mfma_f32_16x16x32_bf16 v[100:103], v[132:135], v[164:167], v[100:103]
    ds_read_b128 v[172:175], v221 offset:16384
    v_mfma_f32_16x16x32_bf16 v[84:87], v[132:135], v[160:163], v[84:87]
    ds_read_b128 v[176:179], v221 offset:18432
    v_mfma_f32_16x16x32_bf16 v[68:71], v[132:135], v[156:159], v[68:71]
    ds_read_b128 v[180:183], v221 offset:20480
    v_mfma_f32_16x16x32_bf16 v[52:55], v[132:135], v[152:155], v[52:55]
    ds_read_b128 v[184:187], v221 offset:22528
    v_mfma_f32_16x16x32_bf16 v[36:39], v[132:135], v[148:151], v[36:39]
    ds_read_b128 v[188:191], v221 offset:24576
    v_mfma_f32_16x16x32_bf16 v[20:23], v[132:135], v[144:147], v[20:23]
    ds_read_b128 v[192:195], v221 offset:26624
    v_mfma_f32_16x16x32_bf16 v[24:27], v[136:139], v[144:147], v[24:27]
    ds_read_b128 v[196:199], v221 offset:28672
    v_mfma_f32_16x16x32_bf16 v[40:43], v[136:139], v[148:151], v[40:43]
    v_mfma_f32_16x16x32_bf16 v[56:59], v[136:139], v[152:155], v[56:59]
    v_mfma_f32_16x16x32_bf16 v[72:75], v[136:139], v[156:159], v[72:75]
    v_mfma_f32_16x16x32_bf16 v[88:91], v[136:139], v[160:163], v[88:91]
    v_mfma_f32_16x16x32_bf16 v[104:107], v[136:139], v[164:167], v[104:107]
    v_mfma_f32_16x16x32_bf16 v[120:123], v[136:139], v[168:171], v[120:123]
    v_mfma_f32_16x16x32_bf16 v[124:127], v[140:143], v[168:171], v[124:127]
    v_mfma_f32_16x16x32_bf16 v[108:111], v[140:143], v[164:167], v[108:111]
    v_mfma_f32_16x16x32_bf16 v[92:95], v[140:143], v[160:163], v[92:95]
    v_mfma_f32_16x16x32_bf16 v[76:79], v[140:143], v[156:159], v[76:79]
    v_mfma_f32_16x16x32_bf16 v[60:63], v[140:143], v[152:155], v[60:63]
    v_mfma_f32_16x16x32_bf16 v[44:47], v[140:143], v[148:151], v[44:47]
    v_mfma_f32_16x16x32_bf16 v[28:31], v[140:143], v[144:147], v[28:31]
    s_waitcnt lgkmcnt(0)
    s_barrier
    s_setprio 3
    s_waitcnt vmcnt(0)
    v_mfma_f32_16x16x32_bf16 v[16:19], v[200:203], v[172:175], v[16:19]
    ds_read_b64 v[216:217], v249 offset:0
    ds_read_b64 v[218:219], v249 offset:128
    v_mfma_f32_16x16x32_bf16 v[20:23], v[204:207], v[172:175], v[20:23]
    ds_read_b64 v[220:221], v249 offset:256
    ds_read_b64 v[250:251], v249 offset:384
    v_mfma_f32_16x16x32_bf16 v[24:27], v[208:211], v[172:175], v[24:27]
    ds_read_b64 v[252:253], v249 offset:512
    ds_read_b64 v[254:255], v249 offset:640
    v_mfma_f32_16x16x32_bf16 v[28:31], v[212:215], v[172:175], v[28:31]
    ds_read_b64 v[12:13], v249 offset:768
    v_mfma_f32_16x16x32_bf16 v[32:35], v[200:203], v[176:179], v[32:35]
    v_mfma_f32_16x16x32_bf16 v[36:39], v[204:207], v[176:179], v[36:39]
    v_mfma_f32_16x16x32_bf16 v[40:43], v[208:211], v[176:179], v[40:43]
    v_mov_b32_dpp v128, v16 row_newbcast:0 row_mask:0xf bank_mask:0xf
    v_mov_b32_dpp v129, v17 row_newbcast:0 row_mask:0xf bank_mask:0xf
    v_mfma_f32_16x16x32_bf16 v[44:47], v[212:215], v[176:179], v[44:47]
    v_mov_b32_dpp v130, v18 row_newbcast:0 row_mask:0xf bank_mask:0xf
    v_mov_b32_dpp v131, v19 row_newbcast:0 row_mask:0xf bank_mask:0xf
    v_mfma_f32_16x16x32_bf16 v[48:51], v[200:203], v[180:183], v[48:51]
    v_mov_b32_dpp v132, v20 row_newbcast:0 row_mask:0xf bank_mask:0xf
    v_mov_b32_dpp v133, v21 row_newbcast:0 row_mask:0xf bank_mask:0xf
    v_mfma_f32_16x16x32_bf16 v[52:55], v[204:207], v[180:183], v[52:55]
    v_mov_b32_dpp v134, v22 row_newbcast:0 row_mask:0xf bank_mask:0xf
    v_mov_b32_dpp v135, v23 row_newbcast:0 row_mask:0xf bank_mask:0xf
    v_mfma_f32_16x16x32_bf16 v[56:59], v[208:211], v[180:183], v[56:59]
    v_mov_b32_dpp v136, v24 row_newbcast:0 row_mask:0xf bank_mask:0xf
    v_mov_b32_dpp v137, v25 row_newbcast:0 row_mask:0xf bank_mask:0xf
    v_mfma_f32_16x16x32_bf16 v[60:63], v[212:215], v[180:183], v[60:63]
    v_mov_b32_dpp v138, v26 row_newbcast:0 row_mask:0xf bank_mask:0xf
    v_mov_b32_dpp v139, v27 row_newbcast:0 row_mask:0xf bank_mask:0xf
    v_mfma_f32_16x16x32_bf16 v[64:67], v[200:203], v[184:187], v[64:67]
    v_mov_b32_dpp v140, v28 row_newbcast:0 row_mask:0xf bank_mask:0xf
    v_mov_b32_dpp v141, v29 row_newbcast:0 row_mask:0xf bank_mask:0xf
    v_mfma_f32_16x16x32_bf16 v[68:71], v[204:207], v[184:187], v[68:71]
    v_mov_b32_dpp v142, v30 row_newbcast:0 row_mask:0xf bank_mask:0xf
    v_mov_b32_dpp v143, v31 row_newbcast:0 row_mask:0xf bank_mask:0xf
    s_waitcnt lgkmcnt(0)
    v_mfma_f32_16x16x32_bf16 v[72:75], v[208:211], v[184:187], v[72:75]
    v_xor_b32 v144, s60, v217
    v_xor_b32 v145, s60, v219
    v_mfma_f32_16x16x32_bf16 v[76:79], v[212:215], v[184:187], v[76:79]
    v_xor_b32 v146, s60, v221
    v_xor_b32 v147, s60, v251
    v_mfma_f32_16x16x32_bf16 v[80:83], v[200:203], v[188:191], v[80:83]
    v_xor_b32 v148, s60, v253
    v_xor_b32 v149, s60, v255
    v_mfma_f32_16x16x32_bf16 v[84:87], v[204:207], v[188:191], v[84:87]
    v_xor_b32 v150, s60, v13
    v_or3_b32 v144, v144, v145, v146
    v_mfma_f32_16x16x32_bf16 v[88:91], v[208:211], v[188:191], v[88:91]
    v_or3_b32 v147, v147, v148, v149
    v_or3_b32 v144, v144, v147, v150
    v_cmp_ne_u32_e64 vcc, 0, v144
    s_nop 0
    s_cbranch_vccnz P1C_slow
P1C_statok:
    s_mov_b64 vcc, 0xffff
    v_mfma_f32_16x16x32_bf16 v[92:95], v[212:215], v[188:191], v[92:95]
    v_and_b32 v217, s7, v216
    v_rcp_f32 v217, v217
    v_mfma_f32_16x16x32_bf16 v[96:99], v[200:203], v[192:195], v[96:99]
    v_lshlrev_b32 v216, 16, v216
    v_and_b32 v219, s7, v218
    v_mfma_f32_16x16x32_bf16 v[100:103], v[204:207], v[192:195], v[100:103]
    v_rcp_f32 v219, v219
    v_lshlrev_b32 v218, 16, v218
    v_mfma_f32_16x16x32_bf16 v[104:107], v[208:211], v[192:195], v[104:107]
    v_and_b32 v221, s7, v220
    v_rcp_f32 v221, v221
    v_mfma_f32_16x16x32_bf16 v[108:111], v[212:215], v[192:195], v[108:111]
    v_lshlrev_b32 v220, 16, v220
    v_and_b32 v251, s7, v250
    v_mfma_f32_16x16x32_bf16 v[112:115], v[200:203], v[196:199], v[112:115]
    v_rcp_f32 v251, v251
    v_lshlrev_b32 v250, 16, v250
    v_mfma_f32_16x16x32_bf16 v[116:119], v[204:207], v[196:199], v[116:119]
    v_and_b32 v253, s7, v252
    v_rcp_f32 v253, v253
    v_mfma_f32_16x16x32_bf16 v[120:123], v[208:211], v[196:199], v[120:123]
    v_lshlrev_b32 v252, 16, v252
    v_and_b32 v255, s7, v254
    v_mfma_f32_16x16x32_bf16 v[124:127], v[212:215], v[196:199], v[124:127]
    v_rcp_f32 v255, v255
    v_lshlrev_b32 v254, 16, v254
    v_and_b32 v13, s7, v12
    v_rcp_f32 v13, v13
    v_lshlrev_b32_e64 v12, 16, v12
    v_pk_fma_f32 v[16:17], v[216:217], v[128:129], v[16:17] op_sel_hi:[0,1,1] neg_lo:[1,0,0] neg_hi:[1,0,0]
    v_pk_fma_f32 v[18:19], v[216:217], v[130:131], v[18:19] op_sel_hi:[0,1,1] neg_lo:[1,0,0] neg_hi:[1,0,0]
    v_pk_fma_f32 v[20:21], v[216:217], v[132:133], v[20:21] op_sel_hi:[0,1,1] neg_lo:[1,0,0] neg_hi:[1,0,0]
    v_pk_fma_f32 v[22:23], v[216:217], v[134:135], v[22:23] op_sel_hi:[0,1,1] neg_lo:[1,0,0] neg_hi:[1,0,0]
    v_pk_fma_f32 v[24:25], v[216:217], v[136:137], v[24:25] op_sel_hi:[0,1,1] neg_lo:[1,0,0] neg_hi:[1,0,0]
    v_pk_fma_f32 v[26:27], v[216:217], v[138:139], v[26:27] op_sel_hi:[0,1,1] neg_lo:[1,0,0] neg_hi:[1,0,0]
    v_pk_fma_f32 v[28:29], v[216:217], v[140:141], v[28:29] op_sel_hi:[0,1,1] neg_lo:[1,0,0] neg_hi:[1,0,0]
    v_pk_fma_f32 v[30:31], v[216:217], v[142:143], v[30:31] op_sel_hi:[0,1,1] neg_lo:[1,0,0] neg_hi:[1,0,0]
    v_pk_mul_f32 v[16:17], v[16:17], v[216:217] op_sel:[0,1]
    v_pk_mul_f32 v[18:19], v[18:19], v[216:217] op_sel:[0,1]
    v_pk_mul_f32 v[20:21], v[20:21], v[216:217] op_sel:[0,1]
    v_pk_mul_f32 v[22:23], v[22:23], v[216:217] op_sel:[0,1]
    v_pk_mul_f32 v[24:25], v[24:25], v[216:217] op_sel:[0,1]
    v_pk_mul_f32 v[26:27], v[26:27], v[216:217] op_sel:[0,1]
    v_pk_mul_f32 v[28:29], v[28:29], v[216:217] op_sel:[0,1]
    v_pk_mul_f32 v[30:31], v[30:31], v[216:217] op_sel:[0,1]
    v_cvt_pk_bf16_f32 v176, v24, v25
    v_cvt_pk_bf16_f32 v177, v26, v27
    v_cvt_pk_bf16_f32 v174, v28, v29
    v_cvt_pk_bf16_f32 v175, v30, v31
    v_cvt_pk_bf16_f32 v172, v20, v21
    v_cvt_pk_bf16_f32 v173, v22, v23
    v_cvt_pk_bf16_f32 v144, v16, v17
    v_cvt_pk_bf16_f32 v145, v18, v19
    v_cndmask_b32 v146, 0, v176, vcc
    v_cndmask_b32 v147, 0, v177, vcc
    v_pk_fma_f32 v[32:33], v[218:219], v[128:129], v[32:33] op_sel_hi:[0,1,1] neg_lo:[1,0,0] neg_hi:[1,0,0]
    v_pk_fma_f32 v[34:35], v[218:219], v[130:131], v[34:35] op_sel_hi:[0,1,1] neg_lo:[1,0,0] neg_hi:[1,0,0]
    v_pk_fma_f32 v[36:37], v[218:219], v[132:133], v[36:37] op_sel_hi:[0,1,1] neg_lo:[1,0,0] neg_hi:[1,0,0]
    v_pk_fma_f32 v[38:39], v[218:219], v[134:135], v[38:39] op_sel_hi:[0,1,1] neg_lo:[1,0,0] neg_hi:[1,0,0]
    v_pk_fma_f32 v[40:41], v[218:219], v[136:137], v[40:41] op_sel_hi:[0,1,1] neg_lo:[1,0,0] neg_hi:[1,0,0]
    v_pk_fma_f32 v[42:43], v[218:219], v[138:139], v[42:43] op_sel_hi:[0,1,1] neg_lo:[1,0,0] neg_hi:[1,0,0]
    v_pk_fma_f32 v[44:45], v[218:219], v[140:141], v[44:45] op_sel_hi:[0,1,1] neg_lo:[1,0,0] neg_hi:[1,0,0]
    v_pk_fma_f32 v[46:47], v[218:219], v[142:143], v[46:47] op_sel_hi:[0,1,1] neg_lo:[1,0,0] neg_hi:[1,0,0]
    v_pk_mul_f32 v[32:33], v[32:33], v[218:219] op_sel:[0,1]
    v_pk_mul_f32 v[34:35], v[34:35], v[218:219] op_sel:[0,1]
    v_pk_mul_f32 v[36:37], v[36:37], v[218:219] op_sel:[0,1]
    v_pk_mul_f32 v[38:39], v[38:39], v[218:219] op_sel:[0,1]
    v_pk_mul_f32 v[40:41], v[40:41], v[218:219] op_sel:[0,1]
    v_pk_mul_f32 v[42:43], v[42:43], v[218:219] op_sel:[0,1]
    v_pk_mul_f32 v[44:45], v[44:45], v[218:219] op_sel:[0,1]
    v_pk_mul_f32 v[46:47], v[46:47], v[218:219] op_sel:[0,1]
    v_mfma_f32_16x16x32_bf16 v[16:19], v[172:175], v[144:147], v[232:235]
    v_cvt_pk_bf16_f32 v182, v40, v41
    v_cvt_pk_bf16_f32 v183, v42, v43
    v_cvt_pk_bf16_f32 v180, v44, v45
    v_mfma_f32_16x16x32_bf16 v[20:23], v[172:175], v[144:147], v[228:231]
    v_cvt_pk_bf16_f32 v181, v46, v47
    v_cvt_pk_bf16_f32 v178, v36, v37
    v_cvt_pk_bf16_f32 v179, v38, v39
    v_mfma_f32_16x16x32_bf16 v[24:27], v[174:177], v[236:239], 0
    v_cvt_pk_bf16_f32 v148, v32, v33
    v_cvt_pk_bf16_f32 v149, v34, v35
    v_cndmask_b32 v150, 0, v182, vcc
    v_mfma_f32_16x16x32_bf16 v[28:31], v[174:177], v[240:243], 0
    v_cndmask_b32 v151, 0, v183, vcc
    v_pk_fma_f32 v[48:49], v[220:221], v[128:129], v[48:49] op_sel_hi:[0,1,1] neg_lo:[1,0,0] neg_hi:[1,0,0]
    v_pk_fma_f32 v[50:51], v[220:221], v[130:131], v[50:51] op_sel_hi:[0,1,1] neg_lo:[1,0,0] neg_hi:[1,0,0]
    v_pk_fma_f32 v[52:53], v[220:221], v[132:133], v[52:53] op_sel_hi:[0,1,1] neg_lo:[1,0,0] neg_hi:[1,0,0]
    v_pk_fma_f32 v[54:55], v[220:221], v[134:135], v[54:55] op_sel_hi:[0,1,1] neg_lo:[1,0,0] neg_hi:[1,0,0]
    v_pk_fma_f32 v[56:57], v[220:221], v[136:137], v[56:57] op_sel_hi:[0,1,1] neg_lo:[1,0,0] neg_hi:[1,0,0]
    v_pk_fma_f32 v[58:59], v[220:221], v[138:139], v[58:59] op_sel_hi:[0,1,1] neg_lo:[1,0,0] neg_hi:[1,0,0]
    v_pk_fma_f32 v[60:61], v[220:221], v[140:141], v[60:61] op_sel_hi:[0,1,1] neg_lo:[1,0,0] neg_hi:[1,0,0]
    v_pk_fma_f32 v[62:63], v[220:221], v[142:143], v[62:63] op_sel_hi:[0,1,1] neg_lo:[1,0,0] neg_hi:[1,0,0]
    v_pk_mul_f32 v[48:49], v[48:49], v[220:221] op_sel:[0,1]
    v_pk_mul_f32 v[50:51], v[50:51], v[220:221] op_sel:[0,1]
    v_pk_mul_f32 v[52:53], v[52:53], v[220:221] op_sel:[0,1]
    v_pk_mul_f32 v[54:55], v[54:55], v[220:221] op_sel:[0,1]
    v_pk_mul_f32 v[56:57], v[56:57], v[220:221] op_sel:[0,1]
    v_pk_mul_f32 v[58:59], v[58:59], v[220:221] op_sel:[0,1]
    v_pk_mul_f32 v[60:61], v[60:61], v[220:221] op_sel:[0,1]
    v_pk_mul_f32 v[62:63], v[62:63], v[220:221] op_sel:[0,1]
    v_mfma_f32_16x16x32_bf16 v[32:35], v[178:181], v[148:151], v[224:227]
    v_cvt_pk_bf16_f32 v188, v56, v57
    v_cvt_pk_bf16_f32 v189, v58, v59
    v_cvt_pk_bf16_f32 v186, v60, v61
    v_mfma_f32_16x16x32_bf16 v[36:39], v[172:175], v[148:151], v[228:231]
    v_cvt_pk_bf16_f32 v187, v62, v63
    v_cvt_pk_bf16_f32 v184, v52, v53
    v_cvt_pk_bf16_f32 v185, v54, v55
    v_mfma_f32_16x16x32_bf16 v[40:43], v[180:183], v[236:239], 0
    v_cvt_pk_bf16_f32 v152, v48, v49
    v_cvt_pk_bf16_f32 v153, v50, v51
    v_cndmask_b32 v154, 0, v188, vcc
    v_mfma_f32_16x16x32_bf16 v[44:47], v[180:183], v[240:243], 0
    v_cndmask_b32 v155, 0, v189, vcc
    v_pk_fma_f32 v[64:65], v[250:251], v[128:129], v[64:65] op_sel_hi:[0,1,1] neg_lo:[1,0,0] neg_hi:[1,0,0]
    v_pk_fma_f32 v[66:67], v[250:251], v[130:131], v[66:67] op_sel_hi:[0,1,1] neg_lo:[1,0,0] neg_hi:[1,0,0]
    v_pk_fma_f32 v[68:69], v[250:251], v[132:133], v[68:69] op_sel_hi:[0,1,1] neg_lo:[1,0,0] neg_hi:[1,0,0]
    v_pk_fma_f32 v[70:71], v[250:251], v[134:135], v[70:71] op_sel_hi:[0,1,1] neg_lo:[1,0,0] neg_hi:[1,0,0]
    v_pk_fma_f32 v[72:73], v[250:251], v[136:137], v[72:73] op_sel_hi:[0,1,1] neg_lo:[1,0,0] neg_hi:[1,0,0]
    v_pk_fma_f32 v[74:75], v[250:251], v[138:139], v[74:75] op_sel_hi:[0,1,1] neg_lo:[1,0,0] neg_hi:[1,0,0]
    v_pk_fma_f32 v[76:77], v[250:251], v[140:141], v[76:77] op_sel_hi:[0,1,1] neg_lo:[1,0,0] neg_hi:[1,0,0]
    v_pk_fma_f32 v[78:79], v[250:251], v[142:143], v[78:79] op_sel_hi:[0,1,1] neg_lo:[1,0,0] neg_hi:[1,0,0]
    v_pk_mul_f32 v[64:65], v[64:65], v[250:251] op_sel:[0,1]
    v_pk_mul_f32 v[66:67], v[66:67], v[250:251] op_sel:[0,1]
    v_pk_mul_f32 v[68:69], v[68:69], v[250:251] op_sel:[0,1]
    v_pk_mul_f32 v[70:71], v[70:71], v[250:251] op_sel:[0,1]
    v_pk_mul_f32 v[72:73], v[72:73], v[250:251] op_sel:[0,1]
    v_pk_mul_f32 v[74:75], v[74:75], v[250:251] op_sel:[0,1]
    v_pk_mul_f32 v[76:77], v[76:77], v[250:251] op_sel:[0,1]
    v_pk_mul_f32 v[78:79], v[78:79], v[250:251] op_sel:[0,1]
    v_mfma_f32_16x16x32_bf16 v[48:51], v[184:187], v[152:155], v[224:227]
    v_cvt_pk_bf16_f32 v194, v72, v73
    v_cvt_pk_bf16_f32 v195, v74, v75
    v_cvt_pk_bf16_f32 v192, v76, v77
    v_mfma_f32_16x16x32_bf16 v[52:55], v[178:181], v[152:155], v[228:231]
    v_cvt_pk_bf16_f32 v193, v78, v79
    v_cvt_pk_bf16_f32 v190, v68, v69
    v_cvt_pk_bf16_f32 v191, v70, v71
    v_mfma_f32_16x16x32_bf16 v[56:59], v[186:189], v[236:239], 0
    v_cvt_pk_bf16_f32 v156, v64, v65
    v_cvt_pk_bf16_f32 v157, v66, v67
    v_cndmask_b32 v158, 0, v194, vcc
    v_mfma_f32_16x16x32_bf16 v[60:63], v[186:189], v[240:243], 0
    v_cndmask_b32 v159, 0, v195, vcc
    v_pk_fma_f32 v[80:81], v[252:253], v[128:129], v[80:81] op_sel_hi:[0,1,1] neg_lo:[1,0,0] neg_hi:[1,0,0]
    v_pk_fma_f32 v[82:83], v[252:253], v[130:131], v[82:83] op_sel_hi:[0,1,1] neg_lo:[1,0,0] neg_hi:[1,0,0]
    v_pk_fma_f32 v[84:85], v[252:253], v[132:133], v[84:85] op_sel_hi:[0,1,1] neg_lo:[1,0,0] neg_hi:[1,0,0]
    v_pk_fma_f32 v[86:87], v[252:253], v[134:135], v[86:87] op_sel_hi:[0,1,1] neg_lo:[1,0,0] neg_hi:[1,0,0]
    v_pk_fma_f32 v[88:89], v[252:253], v[136:137], v[88:89] op_sel_hi:[0,1,1] neg_lo:[1,0,0] neg_hi:[1,0,0]
    v_pk_fma_f32 v[90:91], v[252:253], v[138:139], v[90:91] op_sel_hi:[0,1,1] neg_lo:[1,0,0] neg_hi:[1,0,0]
    v_pk_fma_f32 v[92:93], v[252:253], v[140:141], v[92:93] op_sel_hi:[0,1,1] neg_lo:[1,0,0] neg_hi:[1,0,0]
    v_pk_fma_f32 v[94:95], v[252:253], v[142:143], v[94:95] op_sel_hi:[0,1,1] neg_lo:[1,0,0] neg_hi:[1,0,0]
    v_pk_mul_f32 v[80:81], v[80:81], v[252:253] op_sel:[0,1]
    v_pk_mul_f32 v[82:83], v[82:83], v[252:253] op_sel:[0,1]
    v_pk_mul_f32 v[84:85], v[84:85], v[252:253] op_sel:[0,1]
    v_pk_mul_f32 v[86:87], v[86:87], v[252:253] op_sel:[0,1]
    v_pk_mul_f32 v[88:89], v[88:89], v[252:253] op_sel:[0,1]
    v_pk_mul_f32 v[90:91], v[90:91], v[252:253] op_sel:[0,1]
    v_pk_mul_f32 v[92:93], v[92:93], v[252:253] op_sel:[0,1]
    v_pk_mul_f32 v[94:95], v[94:95], v[252:253] op_sel:[0,1]
    v_mfma_f32_16x16x32_bf16 v[64:67], v[190:193], v[156:159], v[224:227]
    v_cvt_pk_bf16_f32 v200, v88, v89
    v_cvt_pk_bf16_f32 v201, v90, v91
    v_cvt_pk_bf16_f32 v198, v92, v93
    v_mfma_f32_16x16x32_bf16 v[68:71], v[184:187], v[156:159], v[228:231]
    v_cvt_pk_bf16_f32 v199, v94, v95
    v_cvt_pk_bf16_f32 v196, v84, v85
    v_cvt_pk_bf16_f32 v197, v86, v87
    v_mfma_f32_16x16x32_bf16 v[72:75], v[192:195], v[236:239], 0
    v_cvt_pk_bf16_f32 v160, v80, v81
    v_cvt_pk_bf16_f32 v161, v82, v83
    v_cndmask_b32 v162, 0, v200, vcc
    v_mfma_f32_16x16x32_bf16 v[76:79], v[192:195], v[240:243], 0
    v_cndmask_b32 v163, 0, v201, vcc
    v_pk_fma_f32 v[96:97], v[254:255], v[128:129], v[96:97] op_sel_hi:[0,1,1] neg_lo:[1,0,0] neg_hi:[1,0,0]
    v_pk_fma_f32 v[98:99], v[254:255], v[130:131], v[98:99] op_sel_hi:[0,1,1] neg_lo:[1,0,0] neg_hi:[1,0,0]
    v_pk_fma_f32 v[100:101], v[254:255], v[132:133], v[100:101] op_sel_hi:[0,1,1] neg_lo:[1,0,0] neg_hi:[1,0,0]
    v_pk_fma_f32 v[102:103], v[254:255], v[134:135], v[102:103] op_sel_hi:[0,1,1] neg_lo:[1,0,0] neg_hi:[1,0,0]
    v_pk_fma_f32 v[104:105], v[254:255], v[136:137], v[104:105] op_sel_hi:[0,1,1] neg_lo:[1,0,0] neg_hi:[1,0,0]
    v_pk_fma_f32 v[106:107], v[254:255], v[138:139], v[106:107] op_sel_hi:[0,1,1] neg_lo:[1,0,0] neg_hi:[1,0,0]
    v_pk_fma_f32 v[108:109], v[254:255], v[140:141], v[108:109] op_sel_hi:[0,1,1] neg_lo:[1,0,0] neg_hi:[1,0,0]
    v_pk_fma_f32 v[110:111], v[254:255], v[142:143], v[110:111] op_sel_hi:[0,1,1] neg_lo:[1,0,0] neg_hi:[1,0,0]
    v_pk_mul_f32 v[96:97], v[96:97], v[254:255] op_sel:[0,1]
    v_pk_mul_f32 v[98:99], v[98:99], v[254:255] op_sel:[0,1]
    v_pk_mul_f32 v[100:101], v[100:101], v[254:255] op_sel:[0,1]
    v_pk_mul_f32 v[102:103], v[102:103], v[254:255] op_sel:[0,1]
    v_pk_mul_f32 v[104:105], v[104:105], v[254:255] op_sel:[0,1]
    v_pk_mul_f32 v[106:107], v[106:107], v[254:255] op_sel:[0,1]
    v_pk_mul_f32 v[108:109], v[108:109], v[254:255] op_sel:[0,1]
    v_pk_mul_f32 v[110:111], v[110:111], v[254:255] op_sel:[0,1]
    v_mfma_f32_16x16x32_bf16 v[80:83], v[196:199], v[160:163], v[224:227]
    v_cvt_pk_bf16_f32 v206, v104, v105
    v_cvt_pk_bf16_f32 v207, v106, v107
    v_cvt_pk_bf16_f32 v204, v108, v109
    v_mfma_f32_16x16x32_bf16 v[84:87], v[190:193], v[160:163], v[228:231]
    v_cvt_pk_bf16_f32 v205, v110, v111
    v_cvt_pk_bf16_f32 v202, v100, v101
    v_cvt_pk_bf16_f32 v203, v102, v103
    v_mfma_f32_16x16x32_bf16 v[88:91], v[198:201], v[236:239], 0
    v_cvt_pk_bf16_f32 v164, v96, v97
    v_cvt_pk_bf16_f32 v165, v98, v99
    v_cndmask_b32 v166, 0, v206, vcc
    v_mfma_f32_16x16x32_bf16 v[92:95], v[198:201], v[240:243], 0
    v_cndmask_b32 v167, 0, v207, vcc
    v_pk_fma_f32 v[112:113], v[12:13], v[128:129], v[112:113] op_sel_hi:[0,1,1] neg_lo:[1,0,0] neg_hi:[1,0,0]
    v_pk_fma_f32 v[114:115], v[12:13], v[130:131], v[114:115] op_sel_hi:[0,1,1] neg_lo:[1,0,0] neg_hi:[1,0,0]
    v_pk_fma_f32 v[116:117], v[12:13], v[132:133], v[116:117] op_sel_hi:[0,1,1] neg_lo:[1,0,0] neg_hi:[1,0,0]
    v_pk_fma_f32 v[118:119], v[12:13], v[134:135], v[118:119] op_sel_hi:[0,1,1] neg_lo:[1,0,0] neg_hi:[1,0,0]
    v_pk_fma_f32 v[120:121], v[12:13], v[136:137], v[120:121] op_sel_hi:[0,1,1] neg_lo:[1,0,0] neg_hi:[1,0,0]
    v_pk_fma_f32 v[122:123], v[12:13], v[138:139], v[122:123] op_sel_hi:[0,1,1] neg_lo:[1,0,0] neg_hi:[1,0,0]
    v_pk_fma_f32 v[124:125], v[12:13], v[140:141], v[124:125] op_sel_hi:[0,1,1] neg_lo:[1,0,0] neg_hi:[1,0,0]
    v_pk_fma_f32 v[126:127], v[12:13], v[142:143], v[126:127] op_sel_hi:[0,1,1] neg_lo:[1,0,0] neg_hi:[1,0,0]
    v_pk_mul_f32 v[112:113], v[112:113], v[12:13] op_sel:[0,1]
    v_pk_mul_f32 v[114:115], v[114:115], v[12:13] op_sel:[0,1]
    v_pk_mul_f32 v[116:117], v[116:117], v[12:13] op_sel:[0,1]
    v_pk_mul_f32 v[118:119], v[118:119], v[12:13] op_sel:[0,1]
    v_pk_mul_f32 v[120:121], v[120:121], v[12:13] op_sel:[0,1]
    v_pk_mul_f32 v[122:123], v[122:123], v[12:13] op_sel:[0,1]
    v_pk_mul_f32 v[124:125], v[124:125], v[12:13] op_sel:[0,1]
    v_pk_mul_f32 v[126:127], v[126:127], v[12:13] op_sel:[0,1]
    v_mfma_f32_16x16x32_bf16 v[96:99], v[202:205], v[164:167], v[224:227]
    v_cvt_pk_bf16_f32 v212, v120, v121
    v_cvt_pk_bf16_f32 v213, v122, v123
    v_cvt_pk_bf16_f32 v210, v124, v125
    v_mfma_f32_16x16x32_bf16 v[100:103], v[196:199], v[164:167], v[228:231]
    v_cvt_pk_bf16_f32 v211, v126, v127
    v_cvt_pk_bf16_f32 v208, v116, v117
    v_cvt_pk_bf16_f32 v209, v118, v119
    v_mfma_f32_16x16x32_bf16 v[104:107], v[204:207], v[236:239], 0
    v_cvt_pk_bf16_f32 v168, v112, v113
    v_cvt_pk_bf16_f32 v169, v114, v115
    v_cndmask_b32 v170, 0, v212, vcc
    v_mfma_f32_16x16x32_bf16 v[108:111], v[204:207], v[240:243], 0
    v_cndmask_b32_e64 v171, 0, v213, vcc
    s_nop 1
    v_mfma_f32_16x16x32_bf16 v[112:115], v[208:211], v[168:171], v[224:227]
    v_mfma_f32_16x16x32_bf16 v[116:119], v[202:205], v[168:171], v[228:231]
    v_mfma_f32_16x16x32_bf16 v[120:123], v[210:213], v[236:239], 0
    v_mfma_f32_16x16x32_bf16 v[124:127], v[210:213], v[240:243], 0
    v_mov_b32 v128, 0x3f803f80
    v_mov_b32 v129, 0x3f803f80
    v_mov_b32 v130, 0x3f803f80
    v_mov_b32 v131, 0x3f803f80
    v_cvt_pk_bf16_f32 v146, v24, v25
    v_cvt_pk_bf16_f32 v147, v26, v27
    v_cvt_pk_bf16_f32 v162, v28, v29
    v_cvt_pk_bf16_f32 v163, v30, v31
    v_max_f32 v16, v16, v20
    v_max_f32 v17, v17, v21
    v_max_f32 v18, v18, v22
    v_max_f32 v19, v19, v23
    v_max3_f32 v24, v16, v17, v18
    v_max_f32_e64 v24, v24, v19
    v_cvt_pk_bf16_f32 v148, v40, v41
    v_cvt_pk_bf16_f32 v149, v42, v43
    v_cvt_pk_bf16_f32 v164, v44, v45
    v_cvt_pk_bf16_f32 v165, v46, v47
    v_max_f32 v32, v32, v36
    v_max_f32 v33, v33, v37
    v_max_f32 v34, v34, v38
    v_max_f32 v35, v35, v39
    v_max3_f32 v40, v32, v33, v34
    v_max_f32 v40, v40, v35
    v_mov_b32 v144, v146
    v_mov_b32 v160, v162
    v_mov_b32 v145, v147
    v_mov_b32_e64 v161, v163
    v_cvt_pk_bf16_f32 v150, v56, v57
    v_cvt_pk_bf16_f32 v151, v58, v59
    v_cvt_pk_bf16_f32 v166, v60, v61
    v_cvt_pk_bf16_f32 v167, v62, v63
    v_max_f32 v48, v48, v52
    v_max_f32 v49, v49, v53
    v_max_f32 v50, v50, v54
    v_max_f32 v51, v51, v55
    v_max3_f32 v56, v48, v49, v50
    v_max_f32_e64 v56, v56, v51
    v_cvt_pk_bf16_f32 v152, v72, v73
    v_cvt_pk_bf16_f32 v153, v74, v75
    v_cvt_pk_bf16_f32 v168, v76, v77
    v_cvt_pk_bf16_f32 v169, v78, v79
    v_max_f32 v64, v64, v68
    v_max_f32 v65, v65, v69
    v_max_f32 v66, v66, v70
    v_max_f32 v67, v67, v71
    v_max3_f32 v72, v64, v65, v66
    v_max_f32_e64 v72, v72, v67
    v_cvt_pk_bf16_f32 v154, v88, v89
    v_cvt_pk_bf16_f32 v155, v90, v91
    v_cvt_pk_bf16_f32 v170, v92, v93
    v_cvt_pk_bf16_f32 v171, v94, v95
    v_max_f32 v80, v80, v84
    v_max_f32 v81, v81, v85
    v_max_f32 v82, v82, v86
    v_max_f32 v83, v83, v87
    v_max3_f32 v88, v80, v81, v82
    v_max_f32_e64 v88, v88, v83
    v_cvt_pk_bf16_f32 v156, v104, v105
    v_cvt_pk_bf16_f32 v157, v106, v107
    v_cvt_pk_bf16_f32 v172, v108, v109
    v_cvt_pk_bf16_f32 v173, v110, v111
    v_max_f32 v96, v96, v100
    v_max_f32 v97, v97, v101
    v_max_f32 v98, v98, v102
    v_max_f32 v99, v99, v103
    v_max3_f32 v104, v96, v97, v98
    v_max_f32_e64 v104, v104, v99
    v_cvt_pk_bf16_f32 v158, v120, v121
    v_cvt_pk_bf16_f32 v159, v122, v123
    v_cvt_pk_bf16_f32 v174, v124, v125
    v_cvt_pk_bf16_f32 v175, v126, v127
    v_max_f32 v112, v112, v116
    v_max_f32 v113, v113, v117
    v_max_f32 v114, v114, v118
    v_max_f32 v115, v115, v119
    v_max3_f32 v120, v112, v113, v114
    v_max_f32 v120, v120, v115
    v_mov_b32 v121, v120
    v_permlane32_swap_b32 v24, v40
    v_permlane32_swap_b32 v56, v72
    v_permlane32_swap_b32 v88, v104
    v_permlane32_swap_b32 v120, v121
    v_max_f32 v24, v24, v40
    v_max_f32 v56, v56, v72
    v_max_f32 v88, v88, v104
    v_max_f32 v120, v120, v121
    v_permlane16_swap_b32 v24, v56
    s_nop 0
    v_permlane16_swap_b32 v88, v120
    v_max_f32 v24, v24, v56
    v_max_f32 v88, v88, v120
    v_mul_f32 v56, s58, v24
    v_mul_f32 v24, s58, v24
    v_mul_f32 v120, s58, v88
    v_mul_f32 v88, s58, v88
    v_permlane16_swap_b32 v24, v56
    s_nop 0
    v_permlane16_swap_b32 v88, v120
    v_mov_b32 v40, v24
    v_mov_b32 v72, v56
    v_mov_b32 v104, v88
    v_mov_b32 v121, v120
    v_permlane32_swap_b32 v24, v40
    v_permlane32_swap_b32 v56, v72
    v_permlane32_swap_b32 v88, v104
    v_permlane32_swap_b32 v120, v121
    v_pk_fma_f32 v[16:17], v[16:17], s[58:59], v[24:25] op_sel_hi:[1,0,0] neg_lo:[0,0,1] neg_hi:[0,0,1]
    v_pk_fma_f32 v[18:19], v[18:19], s[58:59], v[24:25] op_sel_hi:[1,0,0] neg_lo:[0,0,1] neg_hi:[0,0,1]
    v_pk_fma_f32 v[32:33], v[32:33], s[58:59], v[40:41] op_sel_hi:[1,0,0] neg_lo:[0,0,1] neg_hi:[0,0,1]
    v_pk_fma_f32 v[34:35], v[34:35], s[58:59], v[40:41] op_sel_hi:[1,0,0] neg_lo:[0,0,1] neg_hi:[0,0,1]
    v_pk_fma_f32 v[48:49], v[48:49], s[58:59], v[56:57] op_sel_hi:[1,0,0] neg_lo:[0,0,1] neg_hi:[0,0,1]
    v_pk_fma_f32 v[50:51], v[50:51], s[58:59], v[56:57] op_sel_hi:[1,0,0] neg_lo:[0,0,1] neg_hi:[0,0,1]
    v_pk_fma_f32 v[64:65], v[64:65], s[58:59], v[72:73] op_sel_hi:[1,0,0] neg_lo:[0,0,1] neg_hi:[0,0,1]
    v_pk_fma_f32 v[66:67], v[66:67], s[58:59], v[72:73] op_sel_hi:[1,0,0] neg_lo:[0,0,1] neg_hi:[0,0,1]
    v_pk_fma_f32 v[80:81], v[80:81], s[58:59], v[88:89] op_sel_hi:[1,0,0] neg_lo:[0,0,1] neg_hi:[0,0,1]
    v_pk_fma_f32 v[82:83], v[82:83], s[58:59], v[88:89] op_sel_hi:[1,0,0] neg_lo:[0,0,1] neg_hi:[0,0,1]
    v_pk_fma_f32 v[96:97], v[96:97], s[58:59], v[104:105] op_sel_hi:[1,0,0] neg_lo:[0,0,1] neg_hi:[0,0,1]
    v_pk_fma_f32 v[98:99], v[98:99], s[58:59], v[104:105] op_sel_hi:[1,0,0] neg_lo:[0,0,1] neg_hi:[0,0,1]
    v_pk_fma_f32 v[112:113], v[112:113], s[58:59], v[120:121] op_sel_hi:[1,0,0] neg_lo:[0,0,1] neg_hi:[0,0,1]
    v_pk_fma_f32 v[114:115], v[114:115], s[58:59], v[120:121] op_sel_hi:[1,0,0] neg_lo:[0,0,1] neg_hi:[0,0,1]
    v_exp_f32 v16, v16
    v_exp_f32 v17, v17
    v_exp_f32 v18, v18
    v_exp_f32 v19, v19
    v_cvt_pk_bf16_f32 v20, v16, v17
    v_cvt_pk_bf16_f32 v21, v18, v19
    v_and_b32 v22, v20, v222
    v_and_b32 v23, v21, v223
    v_xor_b32 v20, v20, v22
    v_xor_b32 v21, v21, v23
    s_nop 1
    v_mfma_f32_16x16x32_bf16 v[24:27], v[128:131], v[20:23], 0
    v_exp_f32 v32, v32
    v_mfma_f32_16x16x32_bf16 v[16:19], v[144:147], v[20:23], 0
    v_exp_f32 v33, v33
    v_mfma_f32_16x16x32_bf16 v[28:31], v[160:163], v[20:23], 0
    v_exp_f32 v34, v34
    v_exp_f32_e64 v35, v35
    v_cvt_pk_bf16_f32 v36, v32, v33
    v_cvt_pk_bf16_f32 v37, v34, v35
    v_and_b32 v38, v36, v222
    v_and_b32 v39, v37, v223
    v_xor_b32 v36, v36, v38
    v_xor_b32 v37, v37, v39
    s_nop 1
    v_mfma_f32_16x16x32_bf16 v[40:43], v[128:131], v[36:39], 0
    v_exp_f32 v48, v48
    v_mfma_f32_16x16x32_bf16 v[32:35], v[146:149], v[36:39], 0
    v_exp_f32 v49, v49
    v_mfma_f32_16x16x32_bf16 v[44:47], v[162:165], v[36:39], 0
    v_exp_f32 v50, v50
    v_exp_f32_e64 v51, v51
    v_cvt_pk_bf16_f32 v52, v48, v49
    v_cvt_pk_bf16_f32 v53, v50, v51
    v_and_b32 v54, v52, v222
    v_and_b32 v55, v53, v223
    v_xor_b32 v52, v52, v54
    v_xor_b32 v53, v53, v55
    s_nop 1
    v_mfma_f32_16x16x32_bf16 v[56:59], v[128:131], v[52:55], 0
    v_exp_f32 v64, v64
    v_mfma_f32_16x16x32_bf16 v[48:51], v[148:151], v[52:55], 0
    v_exp_f32 v65, v65
    v_mfma_f32_16x16x32_bf16 v[60:63], v[164:167], v[52:55], 0
    v_exp_f32 v66, v66
    v_exp_f32_e64 v67, v67
    v_cvt_pk_bf16_f32 v68, v64, v65
    v_cvt_pk_bf16_f32 v69, v66, v67
    v_and_b32 v70, v68, v222
    v_and_b32 v71, v69, v223
    v_xor_b32 v68, v68, v70
    v_xor_b32 v69, v69, v71
    s_nop 1
    v_mfma_f32_16x16x32_bf16 v[72:75], v[128:131], v[68:71], 0
    v_exp_f32 v80, v80
    v_mfma_f32_16x16x32_bf16 v[64:67], v[150:153], v[68:71], 0
    v_exp_f32 v81, v81
    v_mfma_f32_16x16x32_bf16 v[76:79], v[166:169], v[68:71], 0
    v_exp_f32 v82, v82
    v_exp_f32_e64 v83, v83
    v_cvt_pk_bf16_f32 v84, v80, v81
    v_cvt_pk_bf16_f32 v85, v82, v83
    v_and_b32 v86, v84, v222
    v_and_b32 v87, v85, v223
    v_xor_b32 v84, v84, v86
    v_xor_b32 v85, v85, v87
    s_nop 1
    v_mfma_f32_16x16x32_bf16 v[88:91], v[128:131], v[84:87], 0
    v_exp_f32 v96, v96
    v_mfma_f32_16x16x32_bf16 v[80:83], v[152:155], v[84:87], 0
    v_exp_f32 v97, v97
    v_mfma_f32_16x16x32_bf16 v[92:95], v[168:171], v[84:87], 0
    v_exp_f32 v98, v98
    v_exp_f32_e64 v99, v99
    v_cvt_pk_bf16_f32 v100, v96, v97
    v_cvt_pk_bf16_f32 v101, v98, v99
    v_and_b32 v102, v100, v222
    v_and_b32 v103, v101, v223
    v_xor_b32 v100, v100, v102
    v_xor_b32 v101, v101, v103
    s_nop 1
    v_mfma_f32_16x16x32_bf16 v[104:107], v[128:131], v[100:103], 0
    v_exp_f32 v112, v112
    v_mfma_f32_16x16x32_bf16 v[96:99], v[154:157], v[100:103], 0
    v_exp_f32 v113, v113
    v_mfma_f32_16x16x32_bf16 v[108:111], v[170:173], v[100:103], 0
    v_exp_f32 v114, v114
    v_exp_f32_e64 v115, v115
    v_cvt_pk_bf16_f32 v116, v112, v113
    v_cvt_pk_bf16_f32 v117, v114, v115
    v_and_b32 v118, v116, v222
    v_and_b32 v119, v117, v223
    v_xor_b32 v116, v116, v118
    v_xor_b32 v117, v117, v119
    v_rcp_f32 v24, v24
    s_nop 0
    v_pk_mul_f32 v[16:17], v[16:17], v[24:25] op_sel_hi:[1,0]
    v_pk_mul_f32 v[18:19], v[18:19], v[24:25] op_sel_hi:[1,0]
    v_pk_mul_f32 v[28:29], v[28:29], v[24:25] op_sel_hi:[1,0]
    v_pk_mul_f32 v[30:31], v[30:31], v[24:25] op_sel_hi:[1,0]
    v_mfma_f32_16x16x32_bf16 v[120:123], v[128:131], v[116:119], 0
    v_cvt_pk_bf16_f32 v16, v16, v17
    v_mfma_f32_16x16x32_bf16 v[112:115], v[156:159], v[116:119], 0
    v_cvt_pk_bf16_f32 v17, v18, v19
    v_mfma_f32_16x16x32_bf16 v[124:127], v[172:175], v[116:119], 0
    v_cvt_pk_bf16_f32 v28, v28, v29
    v_cvt_pk_bf16_f32 v29, v30, v31
    v_rcp_f32_e64 v40, v40
    ds_write_b64 v244, v[16:17] offset:0
    v_pk_mul_f32 v[32:33], v[32:33], v[40:41] op_sel_hi:[1,0]
    v_pk_mul_f32 v[34:35], v[34:35], v[40:41] op_sel_hi:[1,0]
    v_pk_mul_f32 v[44:45], v[44:45], v[40:41] op_sel_hi:[1,0]
    v_pk_mul_f32 v[46:47], v[46:47], v[40:41] op_sel_hi:[1,0]
    ds_write_b64 v245, v[28:29] offset:0
    v_cvt_pk_bf16_f32 v32, v32, v33
    v_cvt_pk_bf16_f32 v33, v34, v35
    v_cvt_pk_bf16_f32 v44, v44, v45
    v_cvt_pk_bf16_f32 v45, v46, v47
    v_rcp_f32_e64 v56, v56
    ds_write_b64 v244, v[32:33] offset:768
    v_pk_mul_f32 v[48:49], v[48:49], v[56:57] op_sel_hi:[1,0]
    v_pk_mul_f32 v[50:51], v[50:51], v[56:57] op_sel_hi:[1,0]
    v_pk_mul_f32 v[60:61], v[60:61], v[56:57] op_sel_hi:[1,0]
    v_pk_mul_f32 v[62:63], v[62:63], v[56:57] op_sel_hi:[1,0]
    ds_write_b64 v245, v[44:45] offset:768
    v_cvt_pk_bf16_f32 v48, v48, v49
    v_cvt_pk_bf16_f32 v49, v50, v51
    v_cvt_pk_bf16_f32 v60, v60, v61
    v_cvt_pk_bf16_f32 v61, v62, v63
    v_rcp_f32_e64 v72, v72
    ds_write_b64 v244, v[48:49] offset:1536
    v_pk_mul_f32 v[64:65], v[64:65], v[72:73] op_sel_hi:[1,0]
    v_pk_mul_f32 v[66:67], v[66:67], v[72:73] op_sel_hi:[1,0]
    v_pk_mul_f32 v[76:77], v[76:77], v[72:73] op_sel_hi:[1,0]
    v_pk_mul_f32 v[78:79], v[78:79], v[72:73] op_sel_hi:[1,0]
    ds_write_b64 v245, v[60:61] offset:1536
    v_cvt_pk_bf16_f32 v64, v64, v65
    v_cvt_pk_bf16_f32 v65, v66, v67
    v_cvt_pk_bf16_f32 v76, v76, v77
    v_cvt_pk_bf16_f32 v77, v78, v79
    v_rcp_f32_e64 v88, v88
    ds_write_b64 v244, v[64:65] offset:2304
    v_pk_mul_f32 v[80:81], v[80:81], v[88:89] op_sel_hi:[1,0]
    v_pk_mul_f32 v[82:83], v[82:83], v[88:89] op_sel_hi:[1,0]
    v_pk_mul_f32 v[92:93], v[92:93], v[88:89] op_sel_hi:[1,0]
    v_pk_mul_f32 v[94:95], v[94:95], v[88:89] op_sel_hi:[1,0]
    ds_write_b64 v245, v[76:77] offset:2304
    v_cvt_pk_bf16_f32 v80, v80, v81
    v_cvt_pk_bf16_f32 v81, v82, v83
    v_cvt_pk_bf16_f32 v92, v92, v93
    v_cvt_pk_bf16_f32 v93, v94, v95
    v_rcp_f32_e64 v104, v104
    ds_write_b64 v244, v[80:81] offset:3072
    v_pk_mul_f32 v[96:97], v[96:97], v[104:105] op_sel_hi:[1,0]
    v_pk_mul_f32 v[98:99], v[98:99], v[104:105] op_sel_hi:[1,0]
    v_pk_mul_f32 v[108:109], v[108:109], v[104:105] op_sel_hi:[1,0]
    v_pk_mul_f32 v[110:111], v[110:111], v[104:105] op_sel_hi:[1,0]
    ds_write_b64 v245, v[92:93] offset:3072
    v_cvt_pk_bf16_f32 v96, v96, v97
    v_cvt_pk_bf16_f32 v97, v98, v99
    v_cvt_pk_bf16_f32 v108, v108, v109
    v_cvt_pk_bf16_f32 v109, v110, v111
    v_rcp_f32_e64 v120, v120
    ds_write_b64 v244, v[96:97] offset:3840
    v_pk_mul_f32 v[112:113], v[112:113], v[120:121] op_sel_hi:[1,0]
    v_pk_mul_f32 v[114:115], v[114:115], v[120:121] op_sel_hi:[1,0]
    v_pk_mul_f32 v[124:125], v[124:125], v[120:121] op_sel_hi:[1,0]
    v_pk_mul_f32 v[126:127], v[126:127], v[120:121] op_sel_hi:[1,0]
    ds_write_b64 v245, v[108:109] offset:3840
    v_cvt_pk_bf16_f32 v112, v112, v113
    v_cvt_pk_bf16_f32 v113, v114, v115
    v_cvt_pk_bf16_f32 v124, v124, v125
    v_cvt_pk_bf16_f32 v125, v126, v127
    ds_write_b64 v244, v[112:113] offset:4608
    ds_write_b64 v245, v[124:125] offset:4608
    s_waitcnt lgkmcnt(0)
    s_barrier
    ds_read_b64 v[16:17], v246 offset:0
    ds_read_b64 v[18:19], v247 offset:0
    ds_read_b64 v[20:21], v246 offset:1152
    ds_read_b64 v[22:23], v247 offset:1152
    ds_read_b64 v[24:25], v246 offset:2304
    ds_read_b64 v[26:27], v247 offset:2304
    ds_read_b64 v[28:29], v246 offset:3456
    ds_read_b64 v[30:31], v247 offset:3456
    ds_read_b64 v[32:33], v246 offset:4608
    ds_read_b64 v[34:35], v247 offset:4608
    s_movk_i32 s51, 0
    s_waitcnt lgkmcnt(8)
    buffer_store_dwordx4 v[16:19], v248, s[32:35], s51 offen sc1
    s_movk_i32 s51, 3840
    s_waitcnt lgkmcnt(6)
    buffer_store_dwordx4 v[20:23], v248, s[32:35], s51 offen sc1
    s_movk_i32 s51, 7680
    s_waitcnt lgkmcnt(4)
    buffer_store_dwordx4 v[24:27], v248, s[32:35], s51 offen sc1
    s_movk_i32 s51, 11520
    s_waitcnt lgkmcnt(2)
    buffer_store_dwordx4 v[28:31], v248, s[32:35], s51 offen sc1
    s_movk_i32 s51, 15360
    s_waitcnt lgkmcnt(0)
    buffer_store_dwordx4 v[32:35], v248, s[32:35], s51 offen sc1
K_p2C:
    v_mov_b32 v12, s60
    v_and_b32 v40, 1, v3
    v_lshrrev_b32 v41, 1, v3
    v_lshl_add_u32 v40, v40, 1, v41
    s_lshl_b32 s50, s40, 2
    v_add_u32 v40, s50, v40
    v_xor_b32 v40, v40, v6
    v_lshlrev_b32_e64 v40, 4, v40
    v_lshl_add_u32 v40, v6, 8, v40
    v_add_u32 v40, 145408, v40
    ds_read_b128 v[240:243], v40 offset:8192
    v_add_u32 v248, 0x10000, v10
    v_add_u32 v249, 0x10000, v11
    v_add_u32 v250, 0x20000, v10
    v_add_u32 v251, 0x20000, v11
    v_mul_u32_u24 v13, 24576, v2
    s_and_b32 s44, s44, 0xffffff80
    s_waitcnt vmcnt(0) lgkmcnt(0)
    s_barrier
    s_cmp_lg_u32 s3, 4
    s_cbranch_scc1 P2C_noflag
    s_cmp_ge_u32 s5, 20
    s_cbranch_scc1 P2C_noflag
    s_mov_b64 exec, 31
    buffer_atomic_swap v12, v13, s[16:19], s44 offen sc1
    s_mov_b64 exec, -1
P2C_noflag:
    ds_read_b64_tr_b16 v[64:65], v10 offset:0
    ds_read_b64_tr_b16 v[66:67], v10 offset:1024
    ds_read_b64_tr_b16 v[68:69], v11 offset:0
    ds_read_b64_tr_b16 v[70:71], v11 offset:1024
    ds_read_b64_tr_b16 v[72:73], v10 offset:8192
    ds_read_b64_tr_b16 v[74:75], v10 offset:9216
    ds_read_b64_tr_b16 v[76:77], v11 offset:8192
    ds_read_b64_tr_b16 v[78:79], v11 offset:9216
    ds_read_b64_tr_b16 v[80:81], v10 offset:16384
    ds_read_b64_tr_b16 v[82:83], v10 offset:17408
    ds_read_b64_tr_b16 v[84:85], v11 offset:16384
    ds_read_b64_tr_b16 v[86:87], v11 offset:17408
    ds_read_b64_tr_b16 v[88:89], v10 offset:24576
    ds_read_b64_tr_b16 v[90:91], v10 offset:25600
    ds_read_b64_tr_b16 v[92:93], v11 offset:24576
    ds_read_b64_tr_b16 v[94:95], v11 offset:25600
    ds_read_b64_tr_b16 v[96:97], v10 offset:32768
    ds_read_b64_tr_b16 v[98:99], v10 offset:33792
    ds_read_b64_tr_b16 v[100:101], v11 offset:32768
    ds_read_b64_tr_b16 v[102:103], v11 offset:33792
    ds_read_b64_tr_b16 v[104:105], v10 offset:40960
    ds_read_b64_tr_b16 v[106:107], v10 offset:41984
    ds_read_b64_tr_b16 v[108:109], v11 offset:40960
    ds_read_b64_tr_b16 v[110:111], v11 offset:41984
    ds_read_b64_tr_b16 v[112:113], v10 offset:49152
    ds_read_b64_tr_b16 v[114:115], v10 offset:50176
    ds_read_b64_tr_b16 v[116:117], v11 offset:49152
    ds_read_b64_tr_b16 v[118:119], v11 offset:50176
    ds_read_b64_tr_b16 v[120:121], v10 offset:57344
    ds_read_b64_tr_b16 v[122:123], v10 offset:58368
    ds_read_b64_tr_b16 v[124:125], v11 offset:57344
    ds_read_b64_tr_b16 v[126:127], v11 offset:58368
    s_waitcnt lgkmcnt(0)
    s_barrier
    ds_read_b64_tr_b16 v[128:129], v248 offset:0
    ds_read_b64_tr_b16 v[130:131], v248 offset:1024
    ds_read_b64_tr_b16 v[132:133], v249 offset:0
    ds_read_b64_tr_b16 v[134:135], v249 offset:1024
    ds_read_b64_tr_b16 v[136:137], v248 offset:8192
    ds_read_b64_tr_b16 v[138:139], v248 offset:9216
    ds_read_b64_tr_b16 v[140:141], v249 offset:8192
    ds_read_b64_tr_b16 v[142:143], v249 offset:9216
    ds_read_b64_tr_b16 v[144:145], v248 offset:16384
    ds_read_b64_tr_b16 v[146:147], v248 offset:17408
    ds_read_b64_tr_b16 v[148:149], v249 offset:16384
    ds_read_b64_tr_b16 v[150:151], v249 offset:17408
    ds_read_b64_tr_b16 v[152:153], v248 offset:24576
    ds_read_b64_tr_b16 v[154:155], v248 offset:25600
    ds_read_b64_tr_b16 v[156:157], v249 offset:24576
    ds_read_b64_tr_b16 v[158:159], v249 offset:25600
    ds_read_b64_tr_b16 v[160:161], v248 offset:32768
    ds_read_b64_tr_b16 v[162:163], v248 offset:33792
    ds_read_b64_tr_b16 v[164:165], v249 offset:32768
    ds_read_b64_tr_b16 v[166:167], v249 offset:33792
    ds_read_b64_tr_b16 v[168:169], v248 offset:40960
    ds_read_b64_tr_b16 v[170:171], v248 offset:41984
    ds_read_b64_tr_b16 v[172:173], v249 offset:40960
    ds_read_b64_tr_b16 v[174:175], v249 offset:41984
    ds_read_b64_tr_b16 v[176:177], v248 offset:49152
    ds_read_b64_tr_b16 v[178:179], v248 offset:50176
    ds_read_b64_tr_b16 v[180:181], v249 offset:49152
    ds_read_b64_tr_b16 v[182:183], v249 offset:50176
    ds_read_b64_tr_b16 v[184:185], v248 offset:57344
    ds_read_b64_tr_b16 v[186:187], v248 offset:58368
    ds_read_b64_tr_b16 v[188:189], v249 offset:57344
    ds_read_b64_tr_b16 v[190:191], v249 offset:58368
    ds_read_b64_tr_b16 v[192:193], v250 offset:0
    ds_read_b64_tr_b16 v[194:195], v250 offset:1024
    ds_read_b64_tr_b16 v[196:197], v251 offset:0
    ds_read_b64_tr_b16 v[198:199], v251 offset:1024
    ds_read_b64_tr_b16 v[200:201], v250 offset:8192
    ds_read_b64_tr_b16 v[202:203], v250 offset:9216
    ds_read_b64_tr_b16 v[204:205], v251 offset:8192
    ds_read_b64_tr_b16 v[206:207], v251 offset:9216
    ds_read_b64_tr_b16 v[208:209], v250 offset:16384
    ds_read_b64_tr_b16 v[210:211], v250 offset:17408
    ds_read_b64_tr_b16 v[212:213], v251 offset:16384
    ds_read_b64_tr_b16 v[214:215], v251 offset:17408
    ds_read_b64_tr_b16 v[216:217], v250 offset:24576
    ds_read_b64_tr_b16 v[218:219], v250 offset:25600
    ds_read_b64_tr_b16 v[220:221], v251 offset:24576
    ds_read_b64_tr_b16 v[222:223], v251 offset:25600
    s_lshl_b32 s50, s40, 12
    s_add_u32 s50, s50, 65536
    v_lshl_add_u32 v10, v2, 4, s50
    v_lshlrev_b32 v224, 16, v240
    v_and_b32 v225, s7, v240
    v_lshlrev_b32 v226, 16, v241
    v_and_b32 v227, s7, v241
    v_lshlrev_b32 v228, 16, v242
    v_and_b32 v229, s7, v242
    v_lshlrev_b32 v230, 16, v243
    v_and_b32 v231, s7, v243
    s_add_u32 s50, s61, 0
    s_and_b32 s50, s50, 3
    s_mul_i32 s50, s50, 5120
    v_add_u32 v252, s50, v4
    s_add_u32 s50, s61, 1
    s_and_b32 s50, s50, 3
    s_mul_i32 s50, s50, 5120
    v_add_u32 v253, s50, v4
    s_add_u32 s50, s61, 2
    s_and_b32 s50, s50, 3
    s_mul_i32 s50, s50, 5120
    v_add_u32 v254, s50, v4
    s_add_u32 s50, s61, 3
    s_and_b32 s50, s50, 3
    s_mul_i32 s50, s50, 5120
    v_add_u32_e64 v255, s50, v4
    s_waitcnt lgkmcnt(0)
    s_barrier
    ds_read_b128 v[40:43], v252 offset:0
    ds_read_b128 v[44:47], v252 offset:32
    ds_read_b128 v[48:51], v252 offset:64
    ds_read_b128 v[52:55], v252 offset:96
    s_waitcnt lgkmcnt(2)
    s_nop 0
    v_mfma_f32_16x16x32_bf16 v[16:19], v[64:67], v[40:43], 0
    ds_read_b128 v[56:59], v252 offset:128
    v_mfma_f32_16x16x32_bf16 v[20:23], v[68:71], v[40:43], 0
    ds_read_b128 v[60:63], v253 offset:0
    v_mfma_f32_16x16x32_bf16 v[16:19], v[72:75], v[44:47], v[16:19]
    v_mfma_f32_16x16x32_bf16 v[20:23], v[76:79], v[44:47], v[20:23]
    s_waitcnt lgkmcnt(2)
    s_nop 0
    v_mfma_f32_16x16x32_bf16 v[16:19], v[80:83], v[48:51], v[16:19]
    ds_read_b128 v[40:43], v253 offset:32
    v_mfma_f32_16x16x32_bf16 v[20:23], v[84:87], v[48:51], v[20:23]
    ds_read_b128 v[44:47], v253 offset:64
    v_mfma_f32_16x16x32_bf16 v[16:19], v[88:91], v[52:55], v[16:19]
    v_mfma_f32_16x16x32_bf16 v[20:23], v[92:95], v[52:55], v[20:23]
    s_waitcnt lgkmcnt(2)
    s_nop 0
    v_mfma_f32_16x16x32_bf16 v[16:19], v[96:99], v[56:59], v[16:19]
    ds_read_b128 v[48:51], v253 offset:96
    v_mfma_f32_16x16x32_bf16 v[20:23], v[100:103], v[56:59], v[20:23]
    ds_read_b128 v[52:55], v253 offset:128
    v_mfma_f32_16x16x32_bf16 v[16:19], v[104:107], v[60:63], v[16:19]
    v_mfma_f32_16x16x32_bf16 v[20:23], v[108:111], v[60:63], v[20:23]
    s_waitcnt lgkmcnt(2)
    s_nop 0
    v_mfma_f32_16x16x32_bf16 v[16:19], v[112:115], v[40:43], v[16:19]
    ds_read_b128 v[56:59], v254 offset:0
    v_mfma_f32_16x16x32_bf16 v[20:23], v[116:119], v[40:43], v[20:23]
    ds_read_b128 v[60:63], v254 offset:32
    v_mfma_f32_16x16x32_bf16 v[16:19], v[120:123], v[44:47], v[16:19]
    v_mfma_f32_16x16x32_bf16 v[20:23], v[124:127], v[44:47], v[20:23]
    s_waitcnt lgkmcnt(2)
    s_nop 0
    v_mfma_f32_16x16x32_bf16 v[16:19], v[128:131], v[48:51], v[16:19]
    ds_read_b128 v[40:43], v254 offset:64
    v_mfma_f32_16x16x32_bf16 v[20:23], v[132:135], v[48:51], v[20:23]
    ds_read_b128 v[44:47], v254 offset:96
    v_mfma_f32_16x16x32_bf16 v[16:19], v[136:139], v[52:55], v[16:19]
    v_mfma_f32_16x16x32_bf16 v[20:23], v[140:143], v[52:55], v[20:23]
    s_waitcnt lgkmcnt(2)
    s_nop 0
    v_mfma_f32_16x16x32_bf16 v[16:19], v[144:147], v[56:59], v[16:19]
    ds_read_b128 v[48:51], v254 offset:128
    v_mfma_f32_16x16x32_bf16 v[20:23], v[148:151], v[56:59], v[20:23]
    ds_read_b128 v[52:55], v255 offset:0
    v_mfma_f32_16x16x32_bf16 v[16:19], v[152:155], v[60:63], v[16:19]
    v_mfma_f32_16x16x32_bf16 v[20:23], v[156:159], v[60:63], v[20:23]
    s_waitcnt lgkmcnt(2)
    s_nop 0
    v_mfma_f32_16x16x32_bf16 v[16:19], v[160:163], v[40:43], v[16:19]
    ds_read_b128 v[56:59], v255 offset:32
    v_mfma_f32_16x16x32_bf16 v[20:23], v[164:167], v[40:43], v[20:23]
    ds_read_b128 v[60:63], v255 offset:64
    v_mfma_f32_16x16x32_bf16 v[16:19], v[168:171], v[44:47], v[16:19]
    v_mfma_f32_16x16x32_bf16 v[20:23], v[172:175], v[44:47], v[20:23]
    s_waitcnt lgkmcnt(2)
    s_nop 0
    v_mfma_f32_16x16x32_bf16 v[16:19], v[176:179], v[48:51], v[16:19]
    ds_read_b128 v[40:43], v255 offset:96
    v_mfma_f32_16x16x32_bf16 v[20:23], v[180:183], v[48:51], v[20:23]
    ds_read_b128 v[44:47], v255 offset:128
    v_mfma_f32_16x16x32_bf16 v[16:19], v[184:187], v[52:55], v[16:19]
    v_mfma_f32_16x16x32_bf16 v[20:23], v[188:191], v[52:55], v[20:23]
    s_barrier
    s_waitcnt lgkmcnt(2)
    v_mfma_f32_16x16x32_bf16 v[16:19], v[192:195], v[56:59], v[16:19]
    ds_read_b128 v[48:51], v252 offset:20480
    v_mfma_f32_16x16x32_bf16 v[20:23], v[196:199], v[56:59], v[20:23]
    ds_read_b128 v[52:55], v252 offset:20512
    v_mfma_f32_16x16x32_bf16 v[16:19], v[200:203], v[60:63], v[16:19]
    v_mfma_f32_16x16x32_bf16 v[20:23], v[204:207], v[60:63], v[20:23]
    s_waitcnt lgkmcnt(2)
    s_nop 0
    v_mfma_f32_16x16x32_bf16 v[16:19], v[208:211], v[40:43], v[16:19]
    ds_read_b128 v[56:59], v252 offset:20544
    v_mfma_f32_16x16x32_bf16 v[20:23], v[212:215], v[40:43], v[20:23]
    ds_read_b128 v[60:63], v252 offset:20576
    v_mfma_f32_16x16x32_bf16 v[16:19], v[216:219], v[44:47], v[16:19]
    v_mfma_f32_16x16x32_bf16 v[20:23], v[220:223], v[44:47], v[20:23]
    s_waitcnt lgkmcnt(2)
    s_nop 0
    v_mfma_f32_16x16x32_bf16 v[24:27], v[64:67], v[48:51], 0
    ds_read_b128 v[40:43], v252 offset:20608
    v_mfma_f32_16x16x32_bf16 v[28:31], v[68:71], v[48:51], 0
    ds_read_b128 v[44:47], v253 offset:20480
    v_mfma_f32_16x16x32_bf16 v[24:27], v[72:75], v[52:55], v[24:27]
    v_mfma_f32_16x16x32_bf16 v[28:31], v[76:79], v[52:55], v[28:31]
    s_waitcnt lgkmcnt(2)
    s_nop 0
    v_mfma_f32_16x16x32_bf16 v[24:27], v[80:83], v[56:59], v[24:27]
    ds_read_b128 v[48:51], v253 offset:20512
    v_mfma_f32_16x16x32_bf16 v[28:31], v[84:87], v[56:59], v[28:31]
    ds_read_b128 v[52:55], v253 offset:20544
    v_mfma_f32_16x16x32_bf16 v[24:27], v[88:91], v[60:63], v[24:27]
    ds_write_b128 v10, v[16:19] offset:0
    v_mfma_f32_16x16x32_bf16 v[28:31], v[92:95], v[60:63], v[28:31]
    ds_write_b128 v10, v[20:23] offset:1024
    s_waitcnt lgkmcnt(4)
    s_nop 0
    v_mfma_f32_16x16x32_bf16 v[24:27], v[96:99], v[40:43], v[24:27]
    ds_read_b128 v[56:59], v253 offset:20576
    v_mfma_f32_16x16x32_bf16 v[28:31], v[100:103], v[40:43], v[28:31]
    ds_read_b128 v[60:63], v253 offset:20608
    v_mfma_f32_16x16x32_bf16 v[24:27], v[104:107], v[44:47], v[24:27]
    v_mfma_f32_16x16x32_bf16 v[28:31], v[108:111], v[44:47], v[28:31]
    s_waitcnt lgkmcnt(4)
    s_nop 0
    v_mfma_f32_16x16x32_bf16 v[24:27], v[112:115], v[48:51], v[24:27]
    ds_read_b128 v[40:43], v254 offset:20480
    v_mfma_f32_16x16x32_bf16 v[28:31], v[116:119], v[48:51], v[28:31]
    ds_read_b128 v[44:47], v254 offset:20512
    v_mfma_f32_16x16x32_bf16 v[24:27], v[120:123], v[52:55], v[24:27]
    v_mfma_f32_16x16x32_bf16 v[28:31], v[124:127], v[52:55], v[28:31]
    s_waitcnt lgkmcnt(2)
    s_nop 0
    v_mfma_f32_16x16x32_bf16 v[24:27], v[128:131], v[56:59], v[24:27]
    ds_read_b128 v[48:51], v254 offset:20544
    v_mfma_f32_16x16x32_bf16 v[28:31], v[132:135], v[56:59], v[28:31]
    ds_read_b128 v[52:55], v254 offset:20576
    v_mfma_f32_16x16x32_bf16 v[24:27], v[136:139], v[60:63], v[24:27]
    v_mfma_f32_16x16x32_bf16 v[28:31], v[140:143], v[60:63], v[28:31]
    s_waitcnt lgkmcnt(2)
    s_nop 0
    v_mfma_f32_16x16x32_bf16 v[24:27], v[144:147], v[40:43], v[24:27]
    ds_read_b128 v[56:59], v254 offset:20608
    v_mfma_f32_16x16x32_bf16 v[28:31], v[148:151], v[40:43], v[28:31]
    ds_read_b128 v[60:63], v255 offset:20480
    v_mfma_f32_16x16x32_bf16 v[24:27], v[152:155], v[44:47], v[24:27]
    v_mfma_f32_16x16x32_bf16 v[28:31], v[156:159], v[44:47], v[28:31]
    s_barrier
    s_waitcnt lgkmcnt(2)
    v_mfma_f32_16x16x32_bf16 v[24:27], v[160:163], v[48:51], v[24:27]
    ds_read_b128 v[40:43], v255 offset:20512
    v_mfma_f32_16x16x32_bf16 v[28:31], v[164:167], v[48:51], v[28:31]
    ds_read_b128 v[44:47], v255 offset:20544
    v_mfma_f32_16x16x32_bf16 v[24:27], v[168:171], v[52:55], v[24:27]
    v_mfma_f32_16x16x32_bf16 v[28:31], v[172:175], v[52:55], v[28:31]
    s_waitcnt lgkmcnt(2)
    s_nop 0
    v_mfma_f32_16x16x32_bf16 v[24:27], v[176:179], v[56:59], v[24:27]
    ds_read_b128 v[48:51], v255 offset:20576
    v_mfma_f32_16x16x32_bf16 v[28:31], v[180:183], v[56:59], v[28:31]
    ds_read_b128 v[52:55], v255 offset:20608
    v_mfma_f32_16x16x32_bf16 v[24:27], v[184:187], v[60:63], v[24:27]
    v_mfma_f32_16x16x32_bf16 v[28:31], v[188:191], v[60:63], v[28:31]
    s_waitcnt lgkmcnt(2)
    s_nop 0
    v_mfma_f32_16x16x32_bf16 v[24:27], v[192:195], v[40:43], v[24:27]
    ds_read_b128 v[56:59], v252 offset:40960
    v_mfma_f32_16x16x32_bf16 v[28:31], v[196:199], v[40:43], v[28:31]
    ds_read_b128 v[60:63], v252 offset:40992
    v_mfma_f32_16x16x32_bf16 v[24:27], v[200:203], v[44:47], v[24:27]
    v_mfma_f32_16x16x32_bf16 v[28:31], v[204:207], v[44:47], v[28:31]
    s_waitcnt lgkmcnt(2)
    s_nop 0
    v_mfma_f32_16x16x32_bf16 v[24:27], v[208:211], v[48:51], v[24:27]
    ds_read_b128 v[40:43], v252 offset:41024
    v_mfma_f32_16x16x32_bf16 v[28:31], v[212:215], v[48:51], v[28:31]
    ds_read_b128 v[44:47], v252 offset:41056
    v_mfma_f32_16x16x32_bf16 v[24:27], v[216:219], v[52:55], v[24:27]
    v_mfma_f32_16x16x32_bf16 v[28:31], v[220:223], v[52:55], v[28:31]
    s_waitcnt lgkmcnt(2)
    s_nop 0
    v_mfma_f32_16x16x32_bf16 v[32:35], v[64:67], v[56:59], 0
    ds_read_b128 v[48:51], v252 offset:41088
    v_mfma_f32_16x16x32_bf16 v[36:39], v[68:71], v[56:59], 0
    ds_read_b128 v[52:55], v253 offset:40960
    v_mfma_f32_16x16x32_bf16 v[32:35], v[72:75], v[60:63], v[32:35]
    v_mfma_f32_16x16x32_bf16 v[36:39], v[76:79], v[60:63], v[36:39]
    s_waitcnt lgkmcnt(2)
    s_nop 0
    v_mfma_f32_16x16x32_bf16 v[32:35], v[80:83], v[40:43], v[32:35]
    ds_read_b128 v[56:59], v253 offset:40992
    v_mfma_f32_16x16x32_bf16 v[36:39], v[84:87], v[40:43], v[36:39]
    ds_read_b128 v[60:63], v253 offset:41024
    v_mfma_f32_16x16x32_bf16 v[32:35], v[88:91], v[44:47], v[32:35]
    ds_write_b128 v10, v[24:27] offset:2048
    v_mfma_f32_16x16x32_bf16 v[36:39], v[92:95], v[44:47], v[36:39]
    ds_write_b128 v10, v[28:31] offset:3072
    s_waitcnt lgkmcnt(4)
    s_nop 0
    v_mfma_f32_16x16x32_bf16 v[32:35], v[96:99], v[48:51], v[32:35]
    ds_read_b128 v[40:43], v253 offset:41056
    v_mfma_f32_16x16x32_bf16 v[36:39], v[100:103], v[48:51], v[36:39]
    ds_read_b128 v[44:47], v253 offset:41088
    v_mfma_f32_16x16x32_bf16 v[32:35], v[104:107], v[52:55], v[32:35]
    v_mfma_f32_16x16x32_bf16 v[36:39], v[108:111], v[52:55], v[36:39]
    s_waitcnt lgkmcnt(4)
    s_nop 0
    v_mfma_f32_16x16x32_bf16 v[32:35], v[112:115], v[56:59], v[32:35]
    ds_read_b128 v[48:51], v254 offset:40960
    v_mfma_f32_16x16x32_bf16 v[36:39], v[116:119], v[56:59], v[36:39]
    ds_read_b128 v[52:55], v254 offset:40992
    v_mfma_f32_16x16x32_bf16 v[32:35], v[120:123], v[60:63], v[32:35]
    v_mfma_f32_16x16x32_bf16 v[36:39], v[124:127], v[60:63], v[36:39]
    s_waitcnt lgkmcnt(2)
    s_nop 0
    v_mfma_f32_16x16x32_bf16 v[32:35], v[128:131], v[40:43], v[32:35]
    ds_read_b128 v[56:59], v254 offset:41024
    v_mfma_f32_16x16x32_bf16 v[36:39], v[132:135], v[40:43], v[36:39]
    ds_read_b128 v[60:63], v254 offset:41056
    v_mfma_f32_16x16x32_bf16 v[32:35], v[136:139], v[44:47], v[32:35]
    v_mfma_f32_16x16x32_bf16 v[36:39], v[140:143], v[44:47], v[36:39]
    s_waitcnt lgkmcnt(2)
    s_nop 0
    v_mfma_f32_16x16x32_bf16 v[32:35], v[144:147], v[48:51], v[32:35]
    ds_read_b128 v[40:43], v254 offset:41088
    v_mfma_f32_16x16x32_bf16 v[36:39], v[148:151], v[48:51], v[36:39]
    ds_read_b128 v[44:47], v255 offset:40960
    v_mfma_f32_16x16x32_bf16 v[32:35], v[152:155], v[52:55], v[32:35]
    v_mfma_f32_16x16x32_bf16 v[36:39], v[156:159], v[52:55], v[36:39]
    s_barrier
    ds_read_b128 v[244:247], v10 offset:16384
    s_waitcnt lgkmcnt(3)
    v_mfma_f32_16x16x32_bf16 v[32:35], v[160:163], v[56:59], v[32:35]
    ds_read_b128 v[48:51], v255 offset:40992
    v_mfma_f32_16x16x32_bf16 v[36:39], v[164:167], v[56:59], v[36:39]
    ds_read_b128 v[52:55], v255 offset:41024
    v_mfma_f32_16x16x32_bf16 v[32:35], v[168:171], v[60:63], v[32:35]
    v_mfma_f32_16x16x32_bf16 v[36:39], v[172:175], v[60:63], v[36:39]
    s_waitcnt lgkmcnt(3)
    s_nop 0
    v_mfma_f32_16x16x32_bf16 v[32:35], v[176:179], v[40:43], v[32:35]
    ds_read_b128 v[56:59], v255 offset:41056
    v_mfma_f32_16x16x32_bf16 v[36:39], v[180:183], v[40:43], v[36:39]
    ds_read_b128 v[60:63], v255 offset:41088
    v_mfma_f32_16x16x32_bf16 v[32:35], v[184:187], v[44:47], v[32:35]
    v_mfma_f32_16x16x32_bf16 v[36:39], v[188:191], v[44:47], v[36:39]
    s_waitcnt lgkmcnt(2)
    s_nop 0
    v_mfma_f32_16x16x32_bf16 v[32:35], v[192:195], v[48:51], v[32:35]
    v_mfma_f32_16x16x32_bf16 v[36:39], v[196:199], v[48:51], v[36:39]
    v_mfma_f32_16x16x32_bf16 v[32:35], v[200:203], v[52:55], v[32:35]
    v_mfma_f32_16x16x32_bf16 v[36:39], v[204:207], v[52:55], v[36:39]
    s_waitcnt lgkmcnt(0)
    v_mfma_f32_16x16x32_bf16 v[32:35], v[208:211], v[56:59], v[32:35]
    v_lshlrev_b32 v232, 16, v244
    v_and_b32 v233, s7, v244
    v_mfma_f32_16x16x32_bf16 v[36:39], v[212:215], v[56:59], v[36:39]
    v_lshlrev_b32 v234, 16, v245
    v_and_b32 v235, s7, v245
    v_mfma_f32_16x16x32_bf16 v[32:35], v[216:219], v[60:63], v[32:35]
    v_lshlrev_b32 v236, 16, v246
    v_and_b32 v237, s7, v246
    v_mfma_f32_16x16x32_bf16 v[36:39], v[220:223], v[60:63], v[36:39]
    v_lshlrev_b32 v238, 16, v247
    v_and_b32 v239, s7, v247
    s_nop 2
    v_cvt_pk_bf16_f32 v12, v32, v33
    v_cvt_pk_bf16_f32 v13, v34, v35
    s_nop 0
    v_cvt_pk_bf16_f32 v14, v36, v37
    v_cvt_pk_bf16_f32 v15, v38, v39
    s_nop 0
    v_permlane16_swap_b32 v12, v14
    v_permlane16_swap_b32 v13, v15
    v_lshlrev_b32 v32, 16, v12
    v_and_b32 v33, s7, v12
    v_lshlrev_b32 v34, 16, v13
    v_and_b32 v35, s7, v13
    v_lshlrev_b32 v36, 16, v14
    v_and_b32 v37, s7, v14
    v_lshlrev_b32 v38, 16, v15
    v_and_b32 v39, s7, v15
    v_pk_add_f32 v[32:33], v[32:33], v[224:225]
    v_pk_add_f32 v[34:35], v[34:35], v[226:227]
    v_pk_add_f32 v[36:37], v[36:37], v[228:229]
    v_pk_add_f32 v[38:39], v[38:39], v[230:231]
    v_cvt_pk_bf16_f32 v12, v32, v33
    v_cvt_pk_bf16_f32 v13, v34, v35
    v_cvt_pk_bf16_f32 v14, v36, v37
    v_cvt_pk_bf16_f32 v15, v38, v39
    v_lshlrev_b32 v32, 16, v12
    v_and_b32 v33, s7, v12
    v_lshlrev_b32 v34, 16, v13
    v_and_b32 v35, s7, v13
    v_lshlrev_b32 v36, 16, v14
    v_and_b32 v37, s7, v14
    v_lshlrev_b32 v38, 16, v15
    v_and_b32 v39, s7, v15
    v_pk_add_f32 v[32:33], v[32:33], v[232:233]
    v_pk_add_f32 v[34:35], v[34:35], v[234:235]
    v_pk_add_f32 v[36:37], v[36:37], v[236:237]
    v_pk_add_f32 v[38:39], v[38:39], v[238:239]
    v_cvt_pk_bf16_f32 v12, v32, v33
    v_cvt_pk_bf16_f32 v13, v34, v35
    v_cvt_pk_bf16_f32 v14, v36, v37
    v_cvt_pk_bf16_f32 v15, v38, v39
    buffer_store_dwordx4 v[12:15], v9, s[24:27], 0 offen sc1
K_flush:
    s_endpgm
K_p2L:
    v_and_b32 v40, 1, v3
    v_lshrrev_b32 v41, 1, v3
    v_lshl_add_u32 v40, v40, 1, v41
    s_lshl_b32 s50, s40, 2
    v_add_u32 v40, s50, v40
    v_xor_b32 v40, v40, v6
    v_lshlrev_b32_e64 v40, 4, v40
    v_lshl_add_u32 v40, v6, 8, v40
    v_add_u32 v40, 145408, v40
    ds_read_b128 v[224:227], v40 offset:0
    ds_read_b128 v[232:235], v40 offset:4096
    ds_read_b128 v[240:243], v40 offset:8192
    s_sub_u32 s50, 2047, s42
    v_add_u32 v41, 0, v6
    v_min_u32 v41, s50, v41
    v_lshlrev_b32_e64 v41, 3, v41
    v_add_u32 v41, 157696, v41
    ds_read_b64 v[32:33], v41
    v_add_u32 v41, 16, v6
    v_min_u32 v41, s50, v41
    v_lshlrev_b32_e64 v41, 3, v41
    v_add_u32 v41, 157696, v41
    ds_read_b64 v[34:35], v41
    v_add_u32 v41, 32, v6
    v_min_u32 v41, s50, v41
    v_lshlrev_b32_e64 v41, 3, v41
    v_add_u32 v41, 157696, v41
    ds_read_b64 v[36:37], v41
    v_mov_b32 v41, 158080
    ds_read_b128 v[44:47], v41
    s_waitcnt lgkmcnt(0)
    v_readfirstlane_b32 s56, v44
    v_readfirstlane_b32 s57, v45
    s_and_b32 s50, s56, 0xffff
    s_lshr_b32 s51, s56, 16
    s_sub_u32 s50, s50, s42
    s_sub_u32 s51, s51, s42
    s_min_u32 s50, s50, s51
    s_cmp_lg_u32 s57, s60
    s_cselect_b32 s50, 0, s50
    s_cmp_lt_u32 s50, 48
    s_cselect_b32 s55, 1, 0
    v_and_b32 v54, 1, v3
    v_lshlrev_b32 v54, 6, v54
    v_lshrrev_b32 v55, 1, v3
    v_lshl_add_u32 v54, v55, 5, v54
    s_mov_b32 s59, 262144
XN_pl:
    v_mov_b32 v42, 0
    v_xor_b32 v43, s60, v33
    v_or_b32 v42, v42, v43
    v_xor_b32 v43, s60, v35
    v_or_b32 v42, v42, v43
    v_xor_b32 v43, s60, v37
    v_or_b32 v42, v42, v43
    v_cmp_ne_u32 vcc, 0, v42
    s_nop 0
    s_cbranch_vccz XN_okl
    s_sleep 2
    v_add_u32 v24, 0, v1
    v_min_u32 v24, 2047, v24
    v_lshlrev_b32 v24, 3, v24
    buffer_load_dwordx2 v[32:33], v24, s[16:19], 0 offen sc1
    v_add_u32 v24, 16, v1
    v_min_u32 v24, 2047, v24
    v_lshlrev_b32 v24, 3, v24
    buffer_load_dwordx2 v[34:35], v24, s[16:19], 0 offen sc1
    v_add_u32 v24, 32, v1
    v_min_u32 v24, 2047, v24
    v_lshlrev_b32 v24, 3, v24
    buffer_load_dwordx2 v[36:37], v24, s[16:19], 0 offen sc1
    s_waitcnt vmcnt(0)
    s_sub_u32 s59, s59, 1
    s_cmp_lg_u32 s59, 0
    s_cbranch_scc1 XN_pl
XN_okl:
    v_and_b32 v33, s7, v32
    v_rcp_f32 v33, v33
    v_lshlrev_b32 v32, 16, v32
    v_and_b32 v35, s7, v34
    v_rcp_f32 v35, v35
    v_lshlrev_b32 v34, 16, v34
    v_and_b32 v37, s7, v36
    v_rcp_f32 v37, v37
    v_lshlrev_b32 v36, 16, v36
    v_lshlrev_b32 v56, 16, v224
    v_and_b32 v57, s7, v224
    v_lshlrev_b32 v58, 16, v225
    v_and_b32 v59, s7, v225
    v_lshlrev_b32 v60, 16, v226
    v_and_b32 v61, s7, v226
    v_lshlrev_b32 v62, 16, v227
    v_and_b32 v63, s7, v227
    v_pk_add_f32 v[56:57], v[56:57], v[32:33] op_sel_hi:[1,0] neg_lo:[0,1] neg_hi:[0,1]
    v_pk_add_f32 v[58:59], v[58:59], v[32:33] op_sel_hi:[1,0] neg_lo:[0,1] neg_hi:[0,1]
    v_pk_add_f32 v[60:61], v[60:61], v[32:33] op_sel_hi:[1,0] neg_lo:[0,1] neg_hi:[0,1]
    v_pk_add_f32 v[62:63], v[62:63], v[32:33] op_sel_hi:[1,0] neg_lo:[0,1] neg_hi:[0,1]
    v_cvt_pk_bf16_f32 v228, v56, v57
    v_cvt_pk_bf16_f32 v229, v58, v59
    v_cvt_pk_bf16_f32 v230, v60, v61
    v_cvt_pk_bf16_f32 v231, v62, v63
    v_lshlrev_b32 v56, 16, v228
    v_and_b32 v57, s7, v228
    v_lshlrev_b32 v58, 16, v229
    v_and_b32 v59, s7, v229
    v_lshlrev_b32 v60, 16, v230
    v_and_b32 v61, s7, v230
    v_lshlrev_b32 v62, 16, v231
    v_and_b32 v63, s7, v231
    v_pk_mul_f32 v[56:57], v[56:57], v[32:33] op_sel:[0,1]
    v_pk_mul_f32 v[58:59], v[58:59], v[32:33] op_sel:[0,1]
    v_pk_mul_f32 v[60:61], v[60:61], v[32:33] op_sel:[0,1]
    v_pk_mul_f32 v[62:63], v[62:63], v[32:33] op_sel:[0,1]
    v_cvt_pk_bf16_f32 v228, v56, v57
    v_cvt_pk_bf16_f32 v229, v58, v59
    v_cvt_pk_bf16_f32 v230, v60, v61
    v_cvt_pk_bf16_f32 v231, v62, v63
    v_lshlrev_b32 v56, 16, v232
    v_and_b32 v57, s7, v232
    v_lshlrev_b32 v58, 16, v233
    v_and_b32 v59, s7, v233
    v_lshlrev_b32 v60, 16, v234
    v_and_b32 v61, s7, v234
    v_lshlrev_b32 v62, 16, v235
    v_and_b32 v63, s7, v235
    v_pk_add_f32 v[56:57], v[56:57], v[34:35] op_sel_hi:[1,0] neg_lo:[0,1] neg_hi:[0,1]
    v_pk_add_f32 v[58:59], v[58:59], v[34:35] op_sel_hi:[1,0] neg_lo:[0,1] neg_hi:[0,1]
    v_pk_add_f32 v[60:61], v[60:61], v[34:35] op_sel_hi:[1,0] neg_lo:[0,1] neg_hi:[0,1]
    v_pk_add_f32 v[62:63], v[62:63], v[34:35] op_sel_hi:[1,0] neg_lo:[0,1] neg_hi:[0,1]
    v_cvt_pk_bf16_f32 v236, v56, v57
    v_cvt_pk_bf16_f32 v237, v58, v59
    v_cvt_pk_bf16_f32 v238, v60, v61
    v_cvt_pk_bf16_f32 v239, v62, v63
    v_lshlrev_b32 v56, 16, v236
    v_and_b32 v57, s7, v236
    v_lshlrev_b32 v58, 16, v237
    v_and_b32 v59, s7, v237
    v_lshlrev_b32 v60, 16, v238
    v_and_b32 v61, s7, v238
    v_lshlrev_b32 v62, 16, v239
    v_and_b32 v63, s7, v239
    v_pk_mul_f32 v[56:57], v[56:57], v[34:35] op_sel:[0,1]
    v_pk_mul_f32 v[58:59], v[58:59], v[34:35] op_sel:[0,1]
    v_pk_mul_f32 v[60:61], v[60:61], v[34:35] op_sel:[0,1]
    v_pk_mul_f32 v[62:63], v[62:63], v[34:35] op_sel:[0,1]
    v_cvt_pk_bf16_f32 v236, v56, v57
    v_cvt_pk_bf16_f32 v237, v58, v59
    v_cvt_pk_bf16_f32 v238, v60, v61
    v_cvt_pk_bf16_f32 v239, v62, v63
    v_lshlrev_b32 v56, 16, v240
    v_and_b32 v57, s7, v240
    v_lshlrev_b32 v58, 16, v241
    v_and_b32 v59, s7, v241
    v_lshlrev_b32 v60, 16, v242
    v_and_b32 v61, s7, v242
    v_lshlrev_b32 v62, 16, v243
    v_and_b32 v63, s7, v243
    v_pk_add_f32 v[56:57], v[56:57], v[36:37] op_sel_hi:[1,0] neg_lo:[0,1] neg_hi:[0,1]
    v_pk_add_f32 v[58:59], v[58:59], v[36:37] op_sel_hi:[1,0] neg_lo:[0,1] neg_hi:[0,1]
    v_pk_add_f32 v[60:61], v[60:61], v[36:37] op_sel_hi:[1,0] neg_lo:[0,1] neg_hi:[0,1]
    v_pk_add_f32 v[62:63], v[62:63], v[36:37] op_sel_hi:[1,0] neg_lo:[0,1] neg_hi:[0,1]
    v_cvt_pk_bf16_f32 v244, v56, v57
    v_cvt_pk_bf16_f32 v245, v58, v59
    v_cvt_pk_bf16_f32 v246, v60, v61
    v_cvt_pk_bf16_f32 v247, v62, v63
    v_lshlrev_b32 v56, 16, v244
    v_and_b32 v57, s7, v244
    v_lshlrev_b32 v58, 16, v245
    v_and_b32 v59, s7, v245
    v_lshlrev_b32 v60, 16, v246
    v_and_b32 v61, s7, v246
    v_lshlrev_b32 v62, 16, v247
    v_and_b32 v63, s7, v247
    v_pk_mul_f32 v[56:57], v[56:57], v[36:37] op_sel:[0,1]
    v_pk_mul_f32 v[58:59], v[58:59], v[36:37] op_sel:[0,1]
    v_pk_mul_f32 v[60:61], v[60:61], v[36:37] op_sel:[0,1]
    v_pk_mul_f32 v[62:63], v[62:63], v[36:37] op_sel:[0,1]
    v_cvt_pk_bf16_f32 v244, v56, v57
    v_cvt_pk_bf16_f32 v245, v58, v59
    v_cvt_pk_bf16_f32 v246, v60, v61
    v_cvt_pk_bf16_f32 v247, v62, v63
    s_waitcnt vmcnt(0)
    s_barrier
    s_add_u32 s48, s58, 122880
    v_lshl_add_u32 v51, v2, 4, s48
    ds_write_b128 v51, v[64:67] offset:0
    ds_write_b128 v51, v[68:71] offset:4096
    ds_write_b128 v51, v[72:75] offset:8192
    ds_write_b128 v51, v[76:79] offset:12288
    ds_write_b128 v51, v[80:83] offset:16384
    ds_write_b128 v51, v[84:87] offset:20480
    ds_write_b128 v51, v[88:91] offset:24576
    ds_write_b128 v51, v[92:95] offset:28672
    ds_write_b128 v51, v[96:99] offset:32768
    ds_write_b128 v51, v[100:103] offset:36864
    s_mov_b64 exec, 0x1111
    v_mov_b32 v50, 0
    buffer_atomic_or v50, v138, s[16:19], 0 offen sc0 sc1
    s_mov_b64 exec, -1
    s_waitcnt lgkmcnt(0)
    s_barrier
    s_mov_b64 exec, 0x1111
    s_mov_b32 s59, 262144
    s_branch P2L_chk
P2L_poll:
    v_mov_b32 v50, 0
    buffer_atomic_or v50, v138, s[16:19], 0 offen sc0 sc1
P2L_chk:
    s_waitcnt vmcnt(0)
    v_cmp_ne_u32 vcc, s60, v50
    s_nop 0
    s_cbranch_vccz P2L_go
    s_sleep 1
    s_sub_u32 s59, s59, 1
    s_cmp_lg_u32 s59, 0
    s_cbranch_scc1 P2L_poll
P2L_go:
    s_mov_b64 exec, -1
    s_movk_i32 s51, 0
    s_add_u32 m0, s49, 0
    s_nop 0
    buffer_load_dwordx4 v140, s[16:19], s51 offen sc1 lds
    s_add_u32 m0, s49, 1024
    s_nop 0
    buffer_load_dwordx4 v141, s[16:19], s51 offen sc1 lds
    s_add_u32 m0, s49, 2048
    s_nop 0
    buffer_load_dwordx4 v142, s[16:19], s51 offen sc1 lds
    s_add_u32 m0, s49, 3072
    s_nop 0
    buffer_load_dwordx4 v143, s[16:19], s51 offen sc1 lds
    s_add_u32 m0, s49, 4096
    s_nop 0
    buffer_load_dwordx4 v144, s[16:19], s51 offen sc1 lds
    s_movk_i32 s51, 2560
    s_add_u32 m0, s49, 20480
    s_nop 0
    buffer_load_dwordx4 v140, s[16:19], s51 offen sc1 lds
    s_add_u32 m0, s49, 21504
    s_nop 0
    buffer_load_dwordx4 v141, s[16:19], s51 offen sc1 lds
    s_add_u32 m0, s49, 22528
    s_nop 0
    buffer_load_dwordx4 v142, s[16:19], s51 offen sc1 lds
    s_add_u32 m0, s49, 23552
    s_nop 0
    buffer_load_dwordx4 v143, s[16:19], s51 offen sc1 lds
    s_add_u32 m0, s49, 24576
    s_nop 0
    buffer_load_dwordx4 v144, s[16:19], s51 offen sc1 lds
    s_lshl_b32 s50, s40, 12
    s_add_u32 s50, s50, 65536
    v_lshl_add_u32 v51, v2, 4, s50
    v_lshlrev_b32 v96, 16, v224
    v_and_b32 v97, s7, v224
    v_lshlrev_b32 v98, 16, v225
    v_and_b32 v99, s7, v225
    v_lshlrev_b32 v100, 16, v226
    v_and_b32 v101, s7, v226
    v_lshlrev_b32 v102, 16, v227
    v_and_b32 v103, s7, v227
    v_lshlrev_b32 v104, 16, v228
    v_and_b32 v105, s7, v228
    v_lshlrev_b32 v106, 16, v229
    v_and_b32 v107, s7, v229
    v_lshlrev_b32 v108, 16, v230
    v_and_b32 v109, s7, v230
    v_lshlrev_b32 v110, 16, v231
    v_and_b32 v111, s7, v231
    v_lshlrev_b32 v112, 16, v232
    v_and_b32 v113, s7, v232
    v_lshlrev_b32 v114, 16, v233
    v_and_b32 v115, s7, v233
    v_lshlrev_b32 v116, 16, v234
    v_and_b32 v117, s7, v234
    v_lshlrev_b32 v118, 16, v235
    v_and_b32 v119, s7, v235
    v_lshlrev_b32 v120, 16, v236
    v_and_b32 v121, s7, v236
    v_lshlrev_b32 v122, 16, v237
    v_and_b32 v123, s7, v237
    v_lshlrev_b32 v124, 16, v238
    v_and_b32 v125, s7, v238
    v_lshlrev_b32 v126, 16, v239
    v_and_b32 v127, s7, v239
    v_lshlrev_b32 v216, 16, v244
    v_and_b32 v217, s7, v244
    v_lshlrev_b32 v218, 16, v245
    v_and_b32 v219, s7, v245
    v_lshlrev_b32 v220, 16, v246
    v_and_b32 v221, s7, v246
    v_lshlrev_b32 v222, 16, v247
    v_and_b32_e64 v223, s7, v247
    s_waitcnt vmcnt(5)
    s_barrier
    s_movk_i32 s51, 5120
    s_cmp_eq_u32 s61, 42
    s_cselect_b32 s51, 2560, s51
    s_add_u32 m0, s49, 40960
    s_nop 0
    buffer_load_dwordx4 v140, s[16:19], s51 offen sc1 lds
    s_add_u32 m0, s49, 41984
    s_nop 0
    buffer_load_dwordx4 v141, s[16:19], s51 offen sc1 lds
    s_add_u32 m0, s49, 43008
    s_nop 0
    buffer_load_dwordx4 v142, s[16:19], s51 offen sc1 lds
    s_add_u32 m0, s49, 44032
    s_nop 0
    buffer_load_dwordx4 v143, s[16:19], s51 offen sc1 lds
    s_add_u32 m0, s49, 45056
    s_nop 0
    buffer_load_dwordx4 v144, s[16:19], s51 offen sc1 lds
    s_cmp_eq_u32 s55, 0
    s_cbranch_scc1 P2L_plain
    s_mov_b32 s6, 0x10000
    buffer_load_dwordx2 v[44:45], off, s[16:19], s6 sc1
    s_lshl_b32 s6, s43, 1
    s_add_u32 s6, s6, 0x1c000
    buffer_load_dwordx4 v[168:171], v54, s[16:19], s6 offen offset:0 sc1
    buffer_load_dwordx4 v[172:175], v54, s[16:19], s6 offen offset:16 sc1
    buffer_load_dwordx4 v[176:179], v54, s[16:19], s6 offen offset:2560 sc1
    buffer_load_dwordx4 v[180:183], v54, s[16:19], s6 offen offset:2576 sc1
    s_waitcnt vmcnt(10)
    s_barrier
    s_waitcnt vmcnt(5)
    s_barrier
    s_waitcnt vmcnt(0)
    s_nop 0
    s_mov_b32 s59, 262144
UP_p:
    v_min3_u32 v42, v45, v169, v171
    v_max3_u32 v43, v45, v169, v171
    v_min3_u32 v42, v42, v173, v175
    v_max3_u32 v43, v43, v173, v175
    v_min3_u32 v42, v42, v177, v179
    v_max3_u32 v43, v43, v177, v179
    v_min3_u32 v42, v42, v181, v183
    v_max3_u32 v43, v43, v181, v183
    v_readfirstlane_b32 s56, v44
    v_cmp_ne_u32 vcc, s60, v42
    v_cmp_ne_u32 s[52:53], s60, v43
    s_nop 0
    s_or_b64 vcc, vcc, s[52:53]
    s_cbranch_scc1 UP_retry
UP_ok:
    s_and_b32 s50, s56, 0xffff
    s_lshr_b32 s51, s56, 16
    v_cmp_eq_u32 vcc, s50, v1
    v_cmp_eq_u32 s[52:53], s51, v1
    s_nop 0
    s_or_b64 s[56:57], vcc, s[52:53]
    s_cbranch_scc0 UP_n0
    v_cndmask_b32 v20, 0, v176, s[52:53]
    v_cndmask_b32 v20, v20, v168, vcc
    v_cndmask_b32 v21, 0, v178, s[52:53]
    v_cndmask_b32 v21, v21, v170, vcc
    v_cndmask_b32 v22, 0, v180, s[52:53]
    v_cndmask_b32 v22, v22, v172, vcc
    v_cndmask_b32 v23, 0, v182, s[52:53]
    v_cndmask_b32 v23, v23, v174, vcc
    v_lshlrev_b32 v56, 16, v20
    v_and_b32 v57, s7, v20
    v_lshlrev_b32 v58, 16, v21
    v_and_b32 v59, s7, v21
    v_lshlrev_b32 v60, 16, v22
    v_and_b32 v61, s7, v22
    v_lshlrev_b32 v62, 16, v23
    v_and_b32 v63, s7, v23
    v_pk_add_f32 v[104:105], v[104:105], v[56:57]
    v_pk_add_f32 v[106:107], v[106:107], v[58:59]
    v_pk_add_f32 v[108:109], v[108:109], v[60:61]
    v_pk_add_f32 v[110:111], v[110:111], v[62:63]
    v_cvt_pk_bf16_f32 v228, v104, v105
    v_cvt_pk_bf16_f32 v229, v106, v107
    v_cvt_pk_bf16_f32 v230, v108, v109
    v_cvt_pk_bf16_f32 v231, v110, v111
    v_lshlrev_b32 v104, 16, v228
    v_and_b32 v105, s7, v228
    v_lshlrev_b32 v106, 16, v229
    v_and_b32 v107, s7, v229
    v_lshlrev_b32 v108, 16, v230
    v_and_b32 v109, s7, v230
    v_lshlrev_b32 v110, 16, v231
    v_and_b32 v111, s7, v231
UP_n0:
    s_sub_u32 s50, s50, 16
    s_sub_u32 s51, s51, 16
    v_cmp_eq_u32 vcc, s50, v1
    v_cmp_eq_u32 s[52:53], s51, v1
    s_nop 0
    s_or_b64 s[56:57], vcc, s[52:53]
    s_cbranch_scc0 UP_n1
    v_cndmask_b32 v20, 0, v176, s[52:53]
    v_cndmask_b32 v20, v20, v168, vcc
    v_cndmask_b32 v21, 0, v178, s[52:53]
    v_cndmask_b32 v21, v21, v170, vcc
    v_cndmask_b32 v22, 0, v180, s[52:53]
    v_cndmask_b32 v22, v22, v172, vcc
    v_cndmask_b32 v23, 0, v182, s[52:53]
    v_cndmask_b32 v23, v23, v174, vcc
    v_lshlrev_b32 v56, 16, v20
    v_and_b32 v57, s7, v20
    v_lshlrev_b32 v58, 16, v21
    v_and_b32 v59, s7, v21
    v_lshlrev_b32 v60, 16, v22
    v_and_b32 v61, s7, v22
    v_lshlrev_b32 v62, 16, v23
    v_and_b32 v63, s7, v23
    v_pk_add_f32 v[120:121], v[120:121], v[56:57]
    v_pk_add_f32 v[122:123], v[122:123], v[58:59]
    v_pk_add_f32 v[124:125], v[124:125], v[60:61]
    v_pk_add_f32 v[126:127], v[126:127], v[62:63]
    v_cvt_pk_bf16_f32 v236, v120, v121
    v_cvt_pk_bf16_f32 v237, v122, v123
    v_cvt_pk_bf16_f32 v238, v124, v125
    v_cvt_pk_bf16_f32 v239, v126, v127
    v_lshlrev_b32 v120, 16, v236
    v_and_b32 v121, s7, v236
    v_lshlrev_b32 v122, 16, v237
    v_and_b32 v123, s7, v237
    v_lshlrev_b32 v124, 16, v238
    v_and_b32 v125, s7, v238
    v_lshlrev_b32 v126, 16, v239
    v_and_b32 v127, s7, v239
UP_n1:
    s_sub_u32 s50, s50, 16
    s_sub_u32 s51, s51, 16
    v_cmp_eq_u32 vcc, s50, v1
    v_cmp_eq_u32 s[52:53], s51, v1
    s_nop 0
    s_or_b64 s[56:57], vcc, s[52:53]
    s_cbranch_scc0 UP_n2
    v_cndmask_b32 v20, 0, v176, s[52:53]
    v_cndmask_b32 v20, v20, v168, vcc
    v_cndmask_b32 v21, 0, v178, s[52:53]
    v_cndmask_b32 v21, v21, v170, vcc
    v_cndmask_b32 v22, 0, v180, s[52:53]
    v_cndmask_b32 v22, v22, v172, vcc
    v_cndmask_b32 v23, 0, v182, s[52:53]
    v_cndmask_b32 v23, v23, v174, vcc
    v_lshlrev_b32 v56, 16, v20
    v_and_b32 v57, s7, v20
    v_lshlrev_b32 v58, 16, v21
    v_and_b32 v59, s7, v21
    v_lshlrev_b32 v60, 16, v22
    v_and_b32 v61, s7, v22
    v_lshlrev_b32 v62, 16, v23
    v_and_b32 v63, s7, v23
    v_pk_add_f32 v[216:217], v[216:217], v[56:57]
    v_pk_add_f32 v[218:219], v[218:219], v[58:59]
    v_pk_add_f32 v[220:221], v[220:221], v[60:61]
    v_pk_add_f32 v[222:223], v[222:223], v[62:63]
    v_cvt_pk_bf16_f32 v244, v216, v217
    v_cvt_pk_bf16_f32 v245, v218, v219
    v_cvt_pk_bf16_f32 v246, v220, v221
    v_cvt_pk_bf16_f32 v247, v222, v223
UP_n2:
    s_branch P2L_join
P2L_plain:
    s_waitcnt vmcnt(5)
    s_barrier
    s_waitcnt vmcnt(0)
    s_barrier
P2L_join:
    s_nop 0
    ds_read_b128 v[28:31], v51 offset:0
    ds_read_b128 v[32:35], v51 offset:1024
    ds_write_b128 v51, v[244:247] offset:16384
    s_waitcnt lgkmcnt(0)
    s_nop 0
    v_cvt_pk_bf16_f32 v12, v28, v29
    v_cvt_pk_bf16_f32 v13, v30, v31
    v_cvt_pk_bf16_f32 v14, v32, v33
    v_cvt_pk_bf16_f32 v15, v34, v35
    s_nop 0
    v_permlane16_swap_b32 v12, v14
    v_permlane16_swap_b32 v13, v15
    v_lshlrev_b32 v28, 16, v12
    v_and_b32 v29, s7, v12
    v_lshlrev_b32 v30, 16, v13
    v_and_b32 v31, s7, v13
    v_lshlrev_b32 v32, 16, v14
    v_and_b32 v33, s7, v14
    v_lshlrev_b32 v34, 16, v15
    v_and_b32_e64 v35, s7, v15
    v_pk_add_f32 v[28:29], v[28:29], v[96:97]
    v_pk_add_f32 v[30:31], v[30:31], v[98:99]
    v_pk_add_f32 v[32:33], v[32:33], v[100:101]
    v_pk_add_f32 v[34:35], v[34:35], v[102:103]
    v_cvt_pk_bf16_f32 v12, v28, v29
    v_cvt_pk_bf16_f32 v13, v30, v31
    v_cvt_pk_bf16_f32 v14, v32, v33
    v_cvt_pk_bf16_f32 v15, v34, v35
    v_lshlrev_b32 v28, 16, v12
    v_and_b32 v29, s7, v12
    v_lshlrev_b32 v30, 16, v13
    v_and_b32 v31, s7, v13
    v_lshlrev_b32 v32, 16, v14
    v_and_b32 v33, s7, v14
    v_lshlrev_b32 v34, 16, v15
    v_and_b32 v35, s7, v15
    v_pk_add_f32 v[28:29], v[28:29], v[104:105]
    v_pk_add_f32 v[30:31], v[30:31], v[106:107]
    v_pk_add_f32 v[32:33], v[32:33], v[108:109]
    v_pk_add_f32 v[34:35], v[34:35], v[110:111]
    v_cvt_pk_bf16_f32 v12, v28, v29
    v_cvt_pk_bf16_f32 v13, v30, v31
    v_cvt_pk_bf16_f32 v14, v32, v33
    v_cvt_pk_bf16_f32 v15, v34, v35
    buffer_store_dwordx4 v[12:15], v7, s[24:27], 0 offen sc1
    s_barrier
    ds_read_b128 v[28:31], v51 offset:2048
    ds_read_b128 v[32:35], v51 offset:3072
    s_waitcnt lgkmcnt(0)
    v_cvt_pk_bf16_f32 v12, v28, v29
    v_cvt_pk_bf16_f32 v13, v30, v31
    v_cvt_pk_bf16_f32 v14, v32, v33
    v_cvt_pk_bf16_f32 v15, v34, v35
    s_nop 0
    v_permlane16_swap_b32 v12, v14
    v_permlane16_swap_b32 v13, v15
    v_lshlrev_b32 v28, 16, v12
    v_and_b32 v29, s7, v12
    v_lshlrev_b32 v30, 16, v13
    v_and_b32 v31, s7, v13
    v_lshlrev_b32 v32, 16, v14
    v_and_b32 v33, s7, v14
    v_lshlrev_b32 v34, 16, v15
    v_and_b32_e64 v35, s7, v15
    v_pk_add_f32 v[28:29], v[28:29], v[112:113]
    v_pk_add_f32 v[30:31], v[30:31], v[114:115]
    v_pk_add_f32 v[32:33], v[32:33], v[116:117]
    v_pk_add_f32 v[34:35], v[34:35], v[118:119]
    v_cvt_pk_bf16_f32 v12, v28, v29
    v_cvt_pk_bf16_f32 v13, v30, v31
    v_cvt_pk_bf16_f32 v14, v32, v33
    v_cvt_pk_bf16_f32 v15, v34, v35
    v_lshlrev_b32 v28, 16, v12
    v_and_b32 v29, s7, v12
    v_lshlrev_b32 v30, 16, v13
    v_and_b32 v31, s7, v13
    v_lshlrev_b32 v32, 16, v14
    v_and_b32 v33, s7, v14
    v_lshlrev_b32 v34, 16, v15
    v_and_b32 v35, s7, v15
    v_pk_add_f32 v[28:29], v[28:29], v[120:121]
    v_pk_add_f32 v[30:31], v[30:31], v[122:123]
    v_pk_add_f32 v[32:33], v[32:33], v[124:125]
    v_pk_add_f32 v[34:35], v[34:35], v[126:127]
    v_cvt_pk_bf16_f32 v12, v28, v29
    v_cvt_pk_bf16_f32 v13, v30, v31
    v_cvt_pk_bf16_f32 v14, v32, v33
    v_cvt_pk_bf16_f32 v15, v34, v35
    buffer_store_dwordx4 v[12:15], v8, s[24:27], 0 offen sc1
    s_branch K_flush
K_other:
    s_cmp_lt_u32 s5, 29
    s_cbranch_scc1 K_other2
    v_mov_b32 v8, 64
    v_mov_b32 v10, 0
    v_mov_b32 v11, 0
    ds_write_b64 v8, v[10:11]
    ds_write_b64 v8, v[10:11] offset:8
    s_waitcnt vmcnt(0) lgkmcnt(0)
    s_barrier
K_other2:
    s_cmp_lt_u32 s3, 4
    s_cbranch_scc1 K_otherL
    s_cmp_ge_u32 s5, 29
    s_cbranch_scc1 K_ffn2
    s_cmp_lt_u32 s5, 21
    s_cbranch_scc1 K_norp
    s_setprio 2
    s_waitcnt lgkmcnt(0)
    s_mov_b32 s8, s64
    s_nop 0
    s_and_b32 s9, s65, 0xffff
    s_mov_b32 s10, 0x280000
    s_mov_b32 s11, 0x20000
    s_add_u32 s48, s84, 0x18000
    s_addc_u32 s49, s85, 0
    s_load_dword s60, s[48:49], 0
    s_and_b32 s52, s4, 3
    s_lshl_b32 s52, s52, 8
    s_sub_u32 s53, s5, 21
    s_lshl_b32 s53, s53, 5
    s_add_u32 s52, s52, s53
    s_sub_u32 s53, s3, 4
    s_lshl_b32 s53, s53, 3
    s_add_u32 s52, s52, s53
    s_mul_i32 s53, s52, 2560
    s_mul_i32 s54, s45, 1280
    s_add_u32 s53, s53, s54
    s_add_u32 s54, s53, 10240
    v_lshlrev_b32 v7, 4, v6
    v_mul_u32_u24 v8, 2560, v3
    v_add_u32 v8, v8, v7
    buffer_load_dwordx4 v[16:19], v8, s[8:11], s53 offen offset:0
    buffer_load_dwordx4 v[20:23], v8, s[8:11], s53 offen offset:256
    buffer_load_dwordx4 v[24:27], v8, s[8:11], s53 offen offset:512
    buffer_load_dwordx4 v[28:31], v8, s[8:11], s53 offen offset:768
    buffer_load_dwordx4 v[32:35], v8, s[8:11], s53 offen offset:1024
    buffer_load_dwordx4 v[36:39], v8, s[8:11], s54 offen offset:0
    buffer_load_dwordx4 v[40:43], v8, s[8:11], s54 offen offset:256
    buffer_load_dwordx4 v[44:47], v8, s[8:11], s54 offen offset:512
    buffer_load_dwordx4 v[48:51], v8, s[8:11], s54 offen offset:768
    buffer_load_dwordx4 v[52:55], v8, s[8:11], s54 offen offset:1024
    s_mov_b32 s28, s72
    s_nop 0
    s_and_b32 s29, s73, 0xffff
    s_mov_b32 s30, 0x500
    s_mov_b32 s31, 0x20000
    buffer_load_dwordx4 v[56:59], v7, s[28:31], 0 offen offset:0
    buffer_load_dwordx4 v[60:63], v7, s[28:31], 0 offen offset:256
    buffer_load_dwordx4 v[64:67], v7, s[28:31], 0 offen offset:512
    buffer_load_dwordx4 v[68:71], v7, s[28:31], 0 offen offset:768
    buffer_load_dwordx4 v[72:75], v7, s[28:31], 0 offen offset:1024
    s_mov_b32 s16, s84
    s_nop 0
    s_and_b32 s17, s85, 0xffff
    s_mov_b32 s18, 0x10000000
    s_mov_b32 s19, 0x20000
    s_lshl_b32 s55, s45, 10
    s_add_u32 s55, s55, s52
    v_lshrrev_b32_e64 v9, 3, v2
    s_mov_b32 s56, 327680
    v_mul_lo_u32 v9, v9, s56
    v_and_b32_e64 v10, 7, v2
    v_lshl_add_u32 v9, v10, 4, v9
    s_mul_i32 s56, s55, 160
    s_add_u32 s56, s56, 0x100000
    v_mov_b32 v132, -1
    v_mov_b32 v133, -1
    v_mov_b32 v134, -1
    v_mov_b32 v135, -1
    s_mov_b32 s56, 0x3acccccd
    s_waitcnt vmcnt(10)
    v_lshlrev_b32 v76, 16, v16
    v_and_b32 v77, s7, v16
    v_lshlrev_b32 v78, 16, v17
    v_and_b32 v79, s7, v17
    v_lshlrev_b32 v80, 16, v18
    v_and_b32 v81, s7, v18
    v_lshlrev_b32 v82, 16, v19
    v_and_b32 v83, s7, v19
    v_lshlrev_b32 v84, 16, v20
    v_and_b32 v85, s7, v20
    v_lshlrev_b32 v86, 16, v21
    v_and_b32 v87, s7, v21
    v_lshlrev_b32 v88, 16, v22
    v_and_b32 v89, s7, v22
    v_lshlrev_b32 v90, 16, v23
    v_and_b32 v91, s7, v23
    v_lshlrev_b32 v92, 16, v24
    v_and_b32 v93, s7, v24
    v_lshlrev_b32 v94, 16, v25
    v_and_b32 v95, s7, v25
    v_lshlrev_b32 v96, 16, v26
    v_and_b32 v97, s7, v26
    v_lshlrev_b32 v98, 16, v27
    v_and_b32 v99, s7, v27
    v_lshlrev_b32 v100, 16, v28
    v_and_b32 v101, s7, v28
    v_lshlrev_b32 v102, 16, v29
    v_and_b32 v103, s7, v29
    v_lshlrev_b32 v104, 16, v30
    v_and_b32 v105, s7, v30
    v_lshlrev_b32 v106, 16, v31
    v_and_b32 v107, s7, v31
    v_lshlrev_b32 v108, 16, v32
    v_and_b32 v109, s7, v32
    v_lshlrev_b32 v110, 16, v33
    v_and_b32 v111, s7, v33
    v_lshlrev_b32 v112, 16, v34
    v_and_b32 v113, s7, v34
    v_lshlrev_b32 v114, 16, v35
    v_and_b32_e64 v115, s7, v35
    v_pk_add_f32 v[120:121], v[76:77], v[78:79]
    v_pk_add_f32 v[122:123], v[80:81], v[82:83]
    v_pk_add_f32 v[120:121], v[120:121], v[84:85]
    v_pk_add_f32 v[122:123], v[122:123], v[86:87]
    v_pk_add_f32 v[120:121], v[120:121], v[88:89]
    v_pk_add_f32 v[122:123], v[122:123], v[90:91]
    v_pk_add_f32 v[120:121], v[120:121], v[92:93]
    v_pk_add_f32 v[122:123], v[122:123], v[94:95]
    v_pk_add_f32 v[120:121], v[120:121], v[96:97]
    v_pk_add_f32 v[122:123], v[122:123], v[98:99]
    v_pk_add_f32 v[120:121], v[120:121], v[100:101]
    v_pk_add_f32 v[122:123], v[122:123], v[102:103]
    v_pk_add_f32 v[120:121], v[120:121], v[104:105]
    v_pk_add_f32 v[122:123], v[122:123], v[106:107]
    v_pk_add_f32 v[120:121], v[120:121], v[108:109]
    v_pk_add_f32 v[122:123], v[122:123], v[110:111]
    v_pk_add_f32 v[120:121], v[120:121], v[112:113]
    v_pk_add_f32 v[122:123], v[122:123], v[114:115]
    v_pk_add_f32 v[120:121], v[120:121], v[122:123]
    v_add_f32 v120, v120, v121
    s_nop 1
    v_add_f32_dpp v120, v120, v120 quad_perm:[1,0,3,2] row_mask:0xf bank_mask:0xf
    s_nop 1
    v_add_f32_dpp v120, v120, v120 quad_perm:[2,3,0,1] row_mask:0xf bank_mask:0xf
    s_nop 1
    v_add_f32_dpp v120, v120, v120 row_half_mirror row_mask:0xf bank_mask:0xf
    s_nop 1
    v_add_f32_dpp v120, v120, v120 row_mirror row_mask:0xf bank_mask:0xf
    v_mul_f32 v124, s56, v120
    v_pk_add_f32 v[126:127], v[76:77], v[124:125] op_sel_hi:[1,0] neg_lo:[0,1] neg_hi:[0,1]
    v_pk_mul_f32 v[120:121], v[126:127], v[126:127]
    v_pk_add_f32 v[128:129], v[78:79], v[124:125] op_sel_hi:[1,0] neg_lo:[0,1] neg_hi:[0,1]
    v_pk_mul_f32 v[122:123], v[128:129], v[128:129]
    v_pk_add_f32 v[126:127], v[80:81], v[124:125] op_sel_hi:[1,0] neg_lo:[0,1] neg_hi:[0,1]
    v_pk_fma_f32 v[120:121], v[126:127], v[126:127], v[120:121]
    v_pk_add_f32 v[128:129], v[82:83], v[124:125] op_sel_hi:[1,0] neg_lo:[0,1] neg_hi:[0,1]
    v_pk_fma_f32 v[122:123], v[128:129], v[128:129], v[122:123]
    v_pk_add_f32 v[126:127], v[84:85], v[124:125] op_sel_hi:[1,0] neg_lo:[0,1] neg_hi:[0,1]
    v_pk_fma_f32 v[120:121], v[126:127], v[126:127], v[120:121]
    v_pk_add_f32 v[128:129], v[86:87], v[124:125] op_sel_hi:[1,0] neg_lo:[0,1] neg_hi:[0,1]
    v_pk_fma_f32 v[122:123], v[128:129], v[128:129], v[122:123]
    v_pk_add_f32 v[126:127], v[88:89], v[124:125] op_sel_hi:[1,0] neg_lo:[0,1] neg_hi:[0,1]
    v_pk_fma_f32 v[120:121], v[126:127], v[126:127], v[120:121]
    v_pk_add_f32 v[128:129], v[90:91], v[124:125] op_sel_hi:[1,0] neg_lo:[0,1] neg_hi:[0,1]
    v_pk_fma_f32 v[122:123], v[128:129], v[128:129], v[122:123]
    v_pk_add_f32 v[126:127], v[92:93], v[124:125] op_sel_hi:[1,0] neg_lo:[0,1] neg_hi:[0,1]
    v_pk_fma_f32 v[120:121], v[126:127], v[126:127], v[120:121]
    v_pk_add_f32 v[128:129], v[94:95], v[124:125] op_sel_hi:[1,0] neg_lo:[0,1] neg_hi:[0,1]
    v_pk_fma_f32 v[122:123], v[128:129], v[128:129], v[122:123]
    v_pk_add_f32 v[126:127], v[96:97], v[124:125] op_sel_hi:[1,0] neg_lo:[0,1] neg_hi:[0,1]
    v_pk_fma_f32 v[120:121], v[126:127], v[126:127], v[120:121]
    v_pk_add_f32 v[128:129], v[98:99], v[124:125] op_sel_hi:[1,0] neg_lo:[0,1] neg_hi:[0,1]
    v_pk_fma_f32 v[122:123], v[128:129], v[128:129], v[122:123]
    v_pk_add_f32 v[126:127], v[100:101], v[124:125] op_sel_hi:[1,0] neg_lo:[0,1] neg_hi:[0,1]
    v_pk_fma_f32 v[120:121], v[126:127], v[126:127], v[120:121]
    v_pk_add_f32 v[128:129], v[102:103], v[124:125] op_sel_hi:[1,0] neg_lo:[0,1] neg_hi:[0,1]
    v_pk_fma_f32 v[122:123], v[128:129], v[128:129], v[122:123]
    v_pk_add_f32 v[126:127], v[104:105], v[124:125] op_sel_hi:[1,0] neg_lo:[0,1] neg_hi:[0,1]
    v_pk_fma_f32 v[120:121], v[126:127], v[126:127], v[120:121]
    v_pk_add_f32 v[128:129], v[106:107], v[124:125] op_sel_hi:[1,0] neg_lo:[0,1] neg_hi:[0,1]
    v_pk_fma_f32 v[122:123], v[128:129], v[128:129], v[122:123]
    v_pk_add_f32 v[126:127], v[108:109], v[124:125] op_sel_hi:[1,0] neg_lo:[0,1] neg_hi:[0,1]
    v_pk_fma_f32 v[120:121], v[126:127], v[126:127], v[120:121]
    v_pk_add_f32 v[128:129], v[110:111], v[124:125] op_sel_hi:[1,0] neg_lo:[0,1] neg_hi:[0,1]
    v_pk_fma_f32 v[122:123], v[128:129], v[128:129], v[122:123]
    v_pk_add_f32 v[126:127], v[112:113], v[124:125] op_sel_hi:[1,0] neg_lo:[0,1] neg_hi:[0,1]
    v_pk_fma_f32 v[120:121], v[126:127], v[126:127], v[120:121]
    v_pk_add_f32 v[128:129], v[114:115], v[124:125] op_sel_hi:[1,0] neg_lo:[0,1] neg_hi:[0,1]
    v_pk_fma_f32 v[122:123], v[128:129], v[128:129], v[122:123]
    v_pk_add_f32 v[120:121], v[120:121], v[122:123]
    v_add_f32 v120, v120, v121
    s_nop 1
    v_add_f32_dpp v120, v120, v120 quad_perm:[1,0,3,2] row_mask:0xf bank_mask:0xf
    s_nop 1
    v_add_f32_dpp v120, v120, v120 quad_perm:[2,3,0,1] row_mask:0xf bank_mask:0xf
    s_nop 1
    v_add_f32_dpp v120, v120, v120 row_half_mirror row_mask:0xf bank_mask:0xf
    s_nop 1
    v_add_f32_dpp v120, v120, v120 row_mirror row_mask:0xf bank_mask:0xf
    v_mul_f32 v120, s56, v120
    v_cvt_pk_bf16_f32 v122, v124, v120
    v_and_b32_e64 v120, s7, v122
    v_add_f32 v120, 0x3727c5ac, v120
    v_cvt_pk_bf16_f32 v120, v120, v120
    v_and_b32 v120, s7, v120
    v_sqrt_f32 v120, v120
    s_nop 0
    v_cvt_pk_bf16_f32 v120, v120, v120
    v_and_b32 v120, s7, v120
    v_rcp_f32 v125, v120
    v_lshlrev_b32 v124, 16, v122
    v_bfi_b32 v10, s7, v120, v122
    v_pk_add_f32 v[76:77], v[76:77], v[124:125] op_sel_hi:[1,0] neg_lo:[0,1] neg_hi:[0,1]
    v_pk_add_f32 v[78:79], v[78:79], v[124:125] op_sel_hi:[1,0] neg_lo:[0,1] neg_hi:[0,1]
    v_pk_add_f32 v[80:81], v[80:81], v[124:125] op_sel_hi:[1,0] neg_lo:[0,1] neg_hi:[0,1]
    v_pk_add_f32 v[82:83], v[82:83], v[124:125] op_sel_hi:[1,0] neg_lo:[0,1] neg_hi:[0,1]
    v_pk_add_f32 v[84:85], v[84:85], v[124:125] op_sel_hi:[1,0] neg_lo:[0,1] neg_hi:[0,1]
    v_pk_add_f32 v[86:87], v[86:87], v[124:125] op_sel_hi:[1,0] neg_lo:[0,1] neg_hi:[0,1]
    v_pk_add_f32 v[88:89], v[88:89], v[124:125] op_sel_hi:[1,0] neg_lo:[0,1] neg_hi:[0,1]
    v_pk_add_f32 v[90:91], v[90:91], v[124:125] op_sel_hi:[1,0] neg_lo:[0,1] neg_hi:[0,1]
    v_pk_add_f32 v[92:93], v[92:93], v[124:125] op_sel_hi:[1,0] neg_lo:[0,1] neg_hi:[0,1]
    v_pk_add_f32 v[94:95], v[94:95], v[124:125] op_sel_hi:[1,0] neg_lo:[0,1] neg_hi:[0,1]
    v_pk_add_f32 v[96:97], v[96:97], v[124:125] op_sel_hi:[1,0] neg_lo:[0,1] neg_hi:[0,1]
    v_pk_add_f32 v[98:99], v[98:99], v[124:125] op_sel_hi:[1,0] neg_lo:[0,1] neg_hi:[0,1]
    v_pk_add_f32 v[100:101], v[100:101], v[124:125] op_sel_hi:[1,0] neg_lo:[0,1] neg_hi:[0,1]
    v_pk_add_f32 v[102:103], v[102:103], v[124:125] op_sel_hi:[1,0] neg_lo:[0,1] neg_hi:[0,1]
    v_pk_add_f32 v[104:105], v[104:105], v[124:125] op_sel_hi:[1,0] neg_lo:[0,1] neg_hi:[0,1]
    v_pk_add_f32 v[106:107], v[106:107], v[124:125] op_sel_hi:[1,0] neg_lo:[0,1] neg_hi:[0,1]
    v_pk_add_f32 v[108:109], v[108:109], v[124:125] op_sel_hi:[1,0] neg_lo:[0,1] neg_hi:[0,1]
    v_pk_add_f32 v[110:111], v[110:111], v[124:125] op_sel_hi:[1,0] neg_lo:[0,1] neg_hi:[0,1]
    v_pk_add_f32 v[112:113], v[112:113], v[124:125] op_sel_hi:[1,0] neg_lo:[0,1] neg_hi:[0,1]
    v_pk_add_f32 v[114:115], v[114:115], v[124:125] op_sel_hi:[1,0] neg_lo:[0,1] neg_hi:[0,1]
    v_cvt_pk_bf16_f32 v16, v76, v77
    v_cvt_pk_bf16_f32 v17, v78, v79
    v_cvt_pk_bf16_f32 v18, v80, v81
    v_cvt_pk_bf16_f32 v19, v82, v83
    v_cvt_pk_bf16_f32 v20, v84, v85
    v_cvt_pk_bf16_f32 v21, v86, v87
    v_cvt_pk_bf16_f32 v22, v88, v89
    v_cvt_pk_bf16_f32 v23, v90, v91
    v_cvt_pk_bf16_f32 v24, v92, v93
    v_cvt_pk_bf16_f32 v25, v94, v95
    v_cvt_pk_bf16_f32 v26, v96, v97
    v_cvt_pk_bf16_f32 v27, v98, v99
    v_cvt_pk_bf16_f32 v28, v100, v101
    v_cvt_pk_bf16_f32 v29, v102, v103
    v_cvt_pk_bf16_f32 v30, v104, v105
    v_cvt_pk_bf16_f32 v31, v106, v107
    v_cvt_pk_bf16_f32 v32, v108, v109
    v_cvt_pk_bf16_f32 v33, v110, v111
    v_cvt_pk_bf16_f32 v34, v112, v113
    v_cvt_pk_bf16_f32 v35, v114, v115
    v_lshlrev_b32 v76, 16, v16
    v_and_b32 v77, s7, v16
    v_lshlrev_b32 v78, 16, v17
    v_and_b32 v79, s7, v17
    v_lshlrev_b32 v80, 16, v18
    v_and_b32 v81, s7, v18
    v_lshlrev_b32 v82, 16, v19
    v_and_b32 v83, s7, v19
    v_lshlrev_b32 v84, 16, v20
    v_and_b32 v85, s7, v20
    v_lshlrev_b32 v86, 16, v21
    v_and_b32 v87, s7, v21
    v_lshlrev_b32 v88, 16, v22
    v_and_b32 v89, s7, v22
    v_lshlrev_b32 v90, 16, v23
    v_and_b32 v91, s7, v23
    v_lshlrev_b32 v92, 16, v24
    v_and_b32 v93, s7, v24
    v_lshlrev_b32 v94, 16, v25
    v_and_b32 v95, s7, v25
    v_lshlrev_b32 v96, 16, v26
    v_and_b32 v97, s7, v26
    v_lshlrev_b32 v98, 16, v27
    v_and_b32 v99, s7, v27
    v_lshlrev_b32 v100, 16, v28
    v_and_b32 v101, s7, v28
    v_lshlrev_b32 v102, 16, v29
    v_and_b32 v103, s7, v29
    v_lshlrev_b32 v104, 16, v30
    v_and_b32 v105, s7, v30
    v_lshlrev_b32 v106, 16, v31
    v_and_b32 v107, s7, v31
    v_lshlrev_b32 v108, 16, v32
    v_and_b32 v109, s7, v32
    v_lshlrev_b32 v110, 16, v33
    v_and_b32 v111, s7, v33
    v_lshlrev_b32 v112, 16, v34
    v_and_b32 v113, s7, v34
    v_lshlrev_b32 v114, 16, v35
    v_and_b32 v115, s7, v35
    v_pk_mul_f32 v[76:77], v[76:77], v[124:125] op_sel:[0,1]
    v_pk_mul_f32 v[78:79], v[78:79], v[124:125] op_sel:[0,1]
    v_pk_mul_f32 v[80:81], v[80:81], v[124:125] op_sel:[0,1]
    v_pk_mul_f32 v[82:83], v[82:83], v[124:125] op_sel:[0,1]
    v_pk_mul_f32 v[84:85], v[84:85], v[124:125] op_sel:[0,1]
    v_pk_mul_f32 v[86:87], v[86:87], v[124:125] op_sel:[0,1]
    v_pk_mul_f32 v[88:89], v[88:89], v[124:125] op_sel:[0,1]
    v_pk_mul_f32 v[90:91], v[90:91], v[124:125] op_sel:[0,1]
    v_pk_mul_f32 v[92:93], v[92:93], v[124:125] op_sel:[0,1]
    v_pk_mul_f32 v[94:95], v[94:95], v[124:125] op_sel:[0,1]
    v_pk_mul_f32 v[96:97], v[96:97], v[124:125] op_sel:[0,1]
    v_pk_mul_f32 v[98:99], v[98:99], v[124:125] op_sel:[0,1]
    v_pk_mul_f32 v[100:101], v[100:101], v[124:125] op_sel:[0,1]
    v_pk_mul_f32 v[102:103], v[102:103], v[124:125] op_sel:[0,1]
    v_pk_mul_f32 v[104:105], v[104:105], v[124:125] op_sel:[0,1]
    v_pk_mul_f32 v[106:107], v[106:107], v[124:125] op_sel:[0,1]
    v_pk_mul_f32 v[108:109], v[108:109], v[124:125] op_sel:[0,1]
    v_pk_mul_f32 v[110:111], v[110:111], v[124:125] op_sel:[0,1]
    v_pk_mul_f32 v[112:113], v[112:113], v[124:125] op_sel:[0,1]
    v_pk_mul_f32 v[114:115], v[114:115], v[124:125] op_sel:[0,1]
    v_cvt_pk_bf16_f32 v16, v76, v77
    v_cvt_pk_bf16_f32 v17, v78, v79
    v_cvt_pk_bf16_f32 v18, v80, v81
    v_cvt_pk_bf16_f32 v19, v82, v83
    v_cvt_pk_bf16_f32 v20, v84, v85
    v_cvt_pk_bf16_f32 v21, v86, v87
    v_cvt_pk_bf16_f32 v22, v88, v89
    v_cvt_pk_bf16_f32 v23, v90, v91
    v_cvt_pk_bf16_f32 v24, v92, v93
    v_cvt_pk_bf16_f32 v25, v94, v95
    v_cvt_pk_bf16_f32 v26, v96, v97
    v_cvt_pk_bf16_f32 v27, v98, v99
    v_cvt_pk_bf16_f32 v28, v100, v101
    v_cvt_pk_bf16_f32 v29, v102, v103
    v_cvt_pk_bf16_f32 v30, v104, v105
    v_cvt_pk_bf16_f32 v31, v106, v107
    v_cvt_pk_bf16_f32 v32, v108, v109
    v_cvt_pk_bf16_f32 v33, v110, v111
    v_cvt_pk_bf16_f32 v34, v112, v113
    v_cvt_pk_bf16_f32 v35, v114, v115
    s_waitcnt vmcnt(0)
    v_mov_b32 v120, 0
    v_mov_b32 v121, 0
    v_dot2c_f32_bf16 v120, v16, v56
    v_dot2c_f32_bf16 v121, v17, v57
    v_dot2c_f32_bf16 v120, v18, v58
    v_dot2c_f32_bf16 v121, v19, v59
    v_dot2c_f32_bf16 v120, v20, v60
    v_dot2c_f32_bf16 v121, v21, v61
    v_dot2c_f32_bf16 v120, v22, v62
    v_dot2c_f32_bf16 v121, v23, v63
    v_dot2c_f32_bf16 v120, v24, v64
    v_dot2c_f32_bf16 v121, v25, v65
    v_dot2c_f32_bf16 v120, v26, v66
    v_dot2c_f32_bf16 v121, v27, v67
    v_dot2c_f32_bf16 v120, v28, v68
    v_dot2c_f32_bf16 v121, v29, v69
    v_dot2c_f32_bf16 v120, v30, v70
    v_dot2c_f32_bf16 v121, v31, v71
    v_dot2c_f32_bf16 v120, v32, v72
    v_dot2c_f32_bf16 v121, v33, v73
    v_dot2c_f32_bf16 v120, v34, v74
    v_dot2c_f32_bf16 v121, v35, v75
    s_nop 2
    v_add_f32 v120, v120, v121
    s_nop 1
    v_add_f32_dpp v120, v120, v120 quad_perm:[1,0,3,2] row_mask:0xf bank_mask:0xf
    s_nop 1
    v_add_f32_dpp v120, v120, v120 quad_perm:[2,3,0,1] row_mask:0xf bank_mask:0xf
    s_nop 1
    v_add_f32_dpp v120, v120, v120 row_half_mirror row_mask:0xf bank_mask:0xf
    s_nop 1
    v_add_f32_dpp v120, v120, v120 row_mirror row_mask:0xf bank_mask:0xf
    v_cvt_pk_bf16_f32 v120, v120, v120
    v_ashrrev_i32 v121, 31, v120
    v_or_b32 v121, 0x80000000, v121
    v_xor_b32 v120, v120, v121
    v_add_u32 v121, s55, v3
    v_bfi_b32 v14, s7, v120, v121
    s_waitcnt lgkmcnt(0)
    s_mul_i32 s60, s60, 1664525
    s_add_u32 s60, s60, 1013904223
    v_mov_b32 v11, s60
    v_mov_b32 v13, s60
    v_lshlrev_b32_e64 v9, 3, v3
    s_lshl_b32 s57, s55, 3
    s_mov_b32 s52, 0x10001
    s_mov_b32 s53, 0x10001
    s_mov_b64 exec, s[52:53]
    buffer_store_dwordx2 v[10:11], v9, s[16:19], s57 offen offset:0 sc1
    s_mov_b64 exec, -1
    v_lshlrev_b32 v76, 16, v36
    v_and_b32 v77, s7, v36
    v_lshlrev_b32 v78, 16, v37
    v_and_b32 v79, s7, v37
    v_lshlrev_b32 v80, 16, v38
    v_and_b32 v81, s7, v38
    v_lshlrev_b32 v82, 16, v39
    v_and_b32 v83, s7, v39
    v_lshlrev_b32 v84, 16, v40
    v_and_b32 v85, s7, v40
    v_lshlrev_b32 v86, 16, v41
    v_and_b32 v87, s7, v41
    v_lshlrev_b32 v88, 16, v42
    v_and_b32 v89, s7, v42
    v_lshlrev_b32 v90, 16, v43
    v_and_b32 v91, s7, v43
    v_lshlrev_b32 v92, 16, v44
    v_and_b32 v93, s7, v44
    v_lshlrev_b32 v94, 16, v45
    v_and_b32 v95, s7, v45
    v_lshlrev_b32 v96, 16, v46
    v_and_b32 v97, s7, v46
    v_lshlrev_b32 v98, 16, v47
    v_and_b32 v99, s7, v47
    v_lshlrev_b32 v100, 16, v48
    v_and_b32 v101, s7, v48
    v_lshlrev_b32 v102, 16, v49
    v_and_b32 v103, s7, v49
    v_lshlrev_b32 v104, 16, v50
    v_and_b32 v105, s7, v50
    v_lshlrev_b32 v106, 16, v51
    v_and_b32 v107, s7, v51
    v_lshlrev_b32 v108, 16, v52
    v_and_b32 v109, s7, v52
    v_lshlrev_b32 v110, 16, v53
    v_and_b32 v111, s7, v53
    v_lshlrev_b32 v112, 16, v54
    v_and_b32 v113, s7, v54
    v_lshlrev_b32 v114, 16, v55
    v_and_b32 v115, s7, v55
    v_pk_add_f32 v[120:121], v[76:77], v[78:79]
    v_pk_add_f32 v[122:123], v[80:81], v[82:83]
    v_pk_add_f32 v[120:121], v[120:121], v[84:85]
    v_pk_add_f32 v[122:123], v[122:123], v[86:87]
    v_pk_add_f32 v[120:121], v[120:121], v[88:89]
    v_pk_add_f32 v[122:123], v[122:123], v[90:91]
    v_pk_add_f32 v[120:121], v[120:121], v[92:93]
    v_pk_add_f32 v[122:123], v[122:123], v[94:95]
    v_pk_add_f32 v[120:121], v[120:121], v[96:97]
    v_pk_add_f32 v[122:123], v[122:123], v[98:99]
    v_pk_add_f32 v[120:121], v[120:121], v[100:101]
    v_pk_add_f32 v[122:123], v[122:123], v[102:103]
    v_pk_add_f32 v[120:121], v[120:121], v[104:105]
    v_pk_add_f32 v[122:123], v[122:123], v[106:107]
    v_pk_add_f32 v[120:121], v[120:121], v[108:109]
    v_pk_add_f32 v[122:123], v[122:123], v[110:111]
    v_pk_add_f32 v[120:121], v[120:121], v[112:113]
    v_pk_add_f32 v[122:123], v[122:123], v[114:115]
    v_pk_add_f32 v[120:121], v[120:121], v[122:123]
    v_add_f32 v120, v120, v121
    s_nop 1
    v_add_f32_dpp v120, v120, v120 quad_perm:[1,0,3,2] row_mask:0xf bank_mask:0xf
    s_nop 1
    v_add_f32_dpp v120, v120, v120 quad_perm:[2,3,0,1] row_mask:0xf bank_mask:0xf
    s_nop 1
    v_add_f32_dpp v120, v120, v120 row_half_mirror row_mask:0xf bank_mask:0xf
    s_nop 1
    v_add_f32_dpp v120, v120, v120 row_mirror row_mask:0xf bank_mask:0xf
    v_mul_f32 v124, s56, v120
    v_pk_add_f32 v[126:127], v[76:77], v[124:125] op_sel_hi:[1,0] neg_lo:[0,1] neg_hi:[0,1]
    v_pk_mul_f32 v[120:121], v[126:127], v[126:127]
    v_pk_add_f32 v[128:129], v[78:79], v[124:125] op_sel_hi:[1,0] neg_lo:[0,1] neg_hi:[0,1]
    v_pk_mul_f32 v[122:123], v[128:129], v[128:129]
    v_pk_add_f32 v[126:127], v[80:81], v[124:125] op_sel_hi:[1,0] neg_lo:[0,1] neg_hi:[0,1]
    v_pk_fma_f32 v[120:121], v[126:127], v[126:127], v[120:121]
    v_pk_add_f32 v[128:129], v[82:83], v[124:125] op_sel_hi:[1,0] neg_lo:[0,1] neg_hi:[0,1]
    v_pk_fma_f32 v[122:123], v[128:129], v[128:129], v[122:123]
    v_pk_add_f32 v[126:127], v[84:85], v[124:125] op_sel_hi:[1,0] neg_lo:[0,1] neg_hi:[0,1]
    v_pk_fma_f32 v[120:121], v[126:127], v[126:127], v[120:121]
    v_pk_add_f32 v[128:129], v[86:87], v[124:125] op_sel_hi:[1,0] neg_lo:[0,1] neg_hi:[0,1]
    v_pk_fma_f32 v[122:123], v[128:129], v[128:129], v[122:123]
    v_pk_add_f32 v[126:127], v[88:89], v[124:125] op_sel_hi:[1,0] neg_lo:[0,1] neg_hi:[0,1]
    v_pk_fma_f32 v[120:121], v[126:127], v[126:127], v[120:121]
    v_pk_add_f32 v[128:129], v[90:91], v[124:125] op_sel_hi:[1,0] neg_lo:[0,1] neg_hi:[0,1]
    v_pk_fma_f32 v[122:123], v[128:129], v[128:129], v[122:123]
    v_pk_add_f32 v[126:127], v[92:93], v[124:125] op_sel_hi:[1,0] neg_lo:[0,1] neg_hi:[0,1]
    v_pk_fma_f32 v[120:121], v[126:127], v[126:127], v[120:121]
    v_pk_add_f32 v[128:129], v[94:95], v[124:125] op_sel_hi:[1,0] neg_lo:[0,1] neg_hi:[0,1]
    v_pk_fma_f32 v[122:123], v[128:129], v[128:129], v[122:123]
    v_pk_add_f32 v[126:127], v[96:97], v[124:125] op_sel_hi:[1,0] neg_lo:[0,1] neg_hi:[0,1]
    v_pk_fma_f32 v[120:121], v[126:127], v[126:127], v[120:121]
    v_pk_add_f32 v[128:129], v[98:99], v[124:125] op_sel_hi:[1,0] neg_lo:[0,1] neg_hi:[0,1]
    v_pk_fma_f32 v[122:123], v[128:129], v[128:129], v[122:123]
    v_pk_add_f32 v[126:127], v[100:101], v[124:125] op_sel_hi:[1,0] neg_lo:[0,1] neg_hi:[0,1]
    v_pk_fma_f32 v[120:121], v[126:127], v[126:127], v[120:121]
    v_pk_add_f32 v[128:129], v[102:103], v[124:125] op_sel_hi:[1,0] neg_lo:[0,1] neg_hi:[0,1]
    v_pk_fma_f32 v[122:123], v[128:129], v[128:129], v[122:123]
    v_pk_add_f32 v[126:127], v[104:105], v[124:125] op_sel_hi:[1,0] neg_lo:[0,1] neg_hi:[0,1]
    v_pk_fma_f32 v[120:121], v[126:127], v[126:127], v[120:121]
    v_pk_add_f32 v[128:129], v[106:107], v[124:125] op_sel_hi:[1,0] neg_lo:[0,1] neg_hi:[0,1]
    v_pk_fma_f32 v[122:123], v[128:129], v[128:129], v[122:123]
    v_pk_add_f32 v[126:127], v[108:109], v[124:125] op_sel_hi:[1,0] neg_lo:[0,1] neg_hi:[0,1]
    v_pk_fma_f32 v[120:121], v[126:127], v[126:127], v[120:121]
    v_pk_add_f32 v[128:129], v[110:111], v[124:125] op_sel_hi:[1,0] neg_lo:[0,1] neg_hi:[0,1]
    v_pk_fma_f32 v[122:123], v[128:129], v[128:129], v[122:123]
    v_pk_add_f32 v[126:127], v[112:113], v[124:125] op_sel_hi:[1,0] neg_lo:[0,1] neg_hi:[0,1]
    v_pk_fma_f32 v[120:121], v[126:127], v[126:127], v[120:121]
    v_pk_add_f32 v[128:129], v[114:115], v[124:125] op_sel_hi:[1,0] neg_lo:[0,1] neg_hi:[0,1]
    v_pk_fma_f32 v[122:123], v[128:129], v[128:129], v[122:123]
    v_pk_add_f32 v[120:121], v[120:121], v[122:123]
    v_add_f32 v120, v120, v121
    s_nop 1
    v_add_f32_dpp v120, v120, v120 quad_perm:[1,0,3,2] row_mask:0xf bank_mask:0xf
    s_nop 1
    v_add_f32_dpp v120, v120, v120 quad_perm:[2,3,0,1] row_mask:0xf bank_mask:0xf
    s_nop 1
    v_add_f32_dpp v120, v120, v120 row_half_mirror row_mask:0xf bank_mask:0xf
    s_nop 1
    v_add_f32_dpp v120, v120, v120 row_mirror row_mask:0xf bank_mask:0xf
    v_mul_f32 v120, s56, v120
    v_cvt_pk_bf16_f32 v122, v124, v120
    v_and_b32_e64 v120, s7, v122
    v_add_f32 v120, 0x3727c5ac, v120
    v_cvt_pk_bf16_f32 v120, v120, v120
    v_and_b32 v120, s7, v120
    v_sqrt_f32 v120, v120
    s_nop 0
    v_cvt_pk_bf16_f32 v120, v120, v120
    v_and_b32 v120, s7, v120
    v_rcp_f32 v125, v120
    v_lshlrev_b32 v124, 16, v122
    v_bfi_b32 v12, s7, v120, v122
    v_pk_add_f32 v[76:77], v[76:77], v[124:125] op_sel_hi:[1,0] neg_lo:[0,1] neg_hi:[0,1]
    v_pk_add_f32 v[78:79], v[78:79], v[124:125] op_sel_hi:[1,0] neg_lo:[0,1] neg_hi:[0,1]
    v_pk_add_f32 v[80:81], v[80:81], v[124:125] op_sel_hi:[1,0] neg_lo:[0,1] neg_hi:[0,1]
    v_pk_add_f32 v[82:83], v[82:83], v[124:125] op_sel_hi:[1,0] neg_lo:[0,1] neg_hi:[0,1]
    v_pk_add_f32 v[84:85], v[84:85], v[124:125] op_sel_hi:[1,0] neg_lo:[0,1] neg_hi:[0,1]
    v_pk_add_f32 v[86:87], v[86:87], v[124:125] op_sel_hi:[1,0] neg_lo:[0,1] neg_hi:[0,1]
    v_pk_add_f32 v[88:89], v[88:89], v[124:125] op_sel_hi:[1,0] neg_lo:[0,1] neg_hi:[0,1]
    v_pk_add_f32 v[90:91], v[90:91], v[124:125] op_sel_hi:[1,0] neg_lo:[0,1] neg_hi:[0,1]
    v_pk_add_f32 v[92:93], v[92:93], v[124:125] op_sel_hi:[1,0] neg_lo:[0,1] neg_hi:[0,1]
    v_pk_add_f32 v[94:95], v[94:95], v[124:125] op_sel_hi:[1,0] neg_lo:[0,1] neg_hi:[0,1]
    v_pk_add_f32 v[96:97], v[96:97], v[124:125] op_sel_hi:[1,0] neg_lo:[0,1] neg_hi:[0,1]
    v_pk_add_f32 v[98:99], v[98:99], v[124:125] op_sel_hi:[1,0] neg_lo:[0,1] neg_hi:[0,1]
    v_pk_add_f32 v[100:101], v[100:101], v[124:125] op_sel_hi:[1,0] neg_lo:[0,1] neg_hi:[0,1]
    v_pk_add_f32 v[102:103], v[102:103], v[124:125] op_sel_hi:[1,0] neg_lo:[0,1] neg_hi:[0,1]
    v_pk_add_f32 v[104:105], v[104:105], v[124:125] op_sel_hi:[1,0] neg_lo:[0,1] neg_hi:[0,1]
    v_pk_add_f32 v[106:107], v[106:107], v[124:125] op_sel_hi:[1,0] neg_lo:[0,1] neg_hi:[0,1]
    v_pk_add_f32 v[108:109], v[108:109], v[124:125] op_sel_hi:[1,0] neg_lo:[0,1] neg_hi:[0,1]
    v_pk_add_f32 v[110:111], v[110:111], v[124:125] op_sel_hi:[1,0] neg_lo:[0,1] neg_hi:[0,1]
    v_pk_add_f32 v[112:113], v[112:113], v[124:125] op_sel_hi:[1,0] neg_lo:[0,1] neg_hi:[0,1]
    v_pk_add_f32 v[114:115], v[114:115], v[124:125] op_sel_hi:[1,0] neg_lo:[0,1] neg_hi:[0,1]
    v_cvt_pk_bf16_f32 v36, v76, v77
    v_cvt_pk_bf16_f32 v37, v78, v79
    v_cvt_pk_bf16_f32 v38, v80, v81
    v_cvt_pk_bf16_f32 v39, v82, v83
    v_cvt_pk_bf16_f32 v40, v84, v85
    v_cvt_pk_bf16_f32 v41, v86, v87
    v_cvt_pk_bf16_f32 v42, v88, v89
    v_cvt_pk_bf16_f32 v43, v90, v91
    v_cvt_pk_bf16_f32 v44, v92, v93
    v_cvt_pk_bf16_f32 v45, v94, v95
    v_cvt_pk_bf16_f32 v46, v96, v97
    v_cvt_pk_bf16_f32 v47, v98, v99
    v_cvt_pk_bf16_f32 v48, v100, v101
    v_cvt_pk_bf16_f32 v49, v102, v103
    v_cvt_pk_bf16_f32 v50, v104, v105
    v_cvt_pk_bf16_f32 v51, v106, v107
    v_cvt_pk_bf16_f32 v52, v108, v109
    v_cvt_pk_bf16_f32 v53, v110, v111
    v_cvt_pk_bf16_f32 v54, v112, v113
    v_cvt_pk_bf16_f32 v55, v114, v115
    v_lshlrev_b32 v76, 16, v36
    v_and_b32 v77, s7, v36
    v_lshlrev_b32 v78, 16, v37
    v_and_b32 v79, s7, v37
    v_lshlrev_b32 v80, 16, v38
    v_and_b32 v81, s7, v38
    v_lshlrev_b32 v82, 16, v39
    v_and_b32 v83, s7, v39
    v_lshlrev_b32 v84, 16, v40
    v_and_b32 v85, s7, v40
    v_lshlrev_b32 v86, 16, v41
    v_and_b32 v87, s7, v41
    v_lshlrev_b32 v88, 16, v42
    v_and_b32 v89, s7, v42
    v_lshlrev_b32 v90, 16, v43
    v_and_b32 v91, s7, v43
    v_lshlrev_b32 v92, 16, v44
    v_and_b32 v93, s7, v44
    v_lshlrev_b32 v94, 16, v45
    v_and_b32 v95, s7, v45
    v_lshlrev_b32 v96, 16, v46
    v_and_b32 v97, s7, v46
    v_lshlrev_b32 v98, 16, v47
    v_and_b32 v99, s7, v47
    v_lshlrev_b32 v100, 16, v48
    v_and_b32 v101, s7, v48
    v_lshlrev_b32 v102, 16, v49
    v_and_b32 v103, s7, v49
    v_lshlrev_b32 v104, 16, v50
    v_and_b32 v105, s7, v50
    v_lshlrev_b32 v106, 16, v51
    v_and_b32 v107, s7, v51
    v_lshlrev_b32 v108, 16, v52
    v_and_b32 v109, s7, v52
    v_lshlrev_b32 v110, 16, v53
    v_and_b32 v111, s7, v53
    v_lshlrev_b32 v112, 16, v54
    v_and_b32 v113, s7, v54
    v_lshlrev_b32 v114, 16, v55
    v_and_b32 v115, s7, v55
    v_pk_mul_f32 v[76:77], v[76:77], v[124:125] op_sel:[0,1]
    v_pk_mul_f32 v[78:79], v[78:79], v[124:125] op_sel:[0,1]
    v_pk_mul_f32 v[80:81], v[80:81], v[124:125] op_sel:[0,1]
    v_pk_mul_f32 v[82:83], v[82:83], v[124:125] op_sel:[0,1]
    v_pk_mul_f32 v[84:85], v[84:85], v[124:125] op_sel:[0,1]
    v_pk_mul_f32 v[86:87], v[86:87], v[124:125] op_sel:[0,1]
    v_pk_mul_f32 v[88:89], v[88:89], v[124:125] op_sel:[0,1]
    v_pk_mul_f32 v[90:91], v[90:91], v[124:125] op_sel:[0,1]
    v_pk_mul_f32 v[92:93], v[92:93], v[124:125] op_sel:[0,1]
    v_pk_mul_f32 v[94:95], v[94:95], v[124:125] op_sel:[0,1]
    v_pk_mul_f32 v[96:97], v[96:97], v[124:125] op_sel:[0,1]
    v_pk_mul_f32 v[98:99], v[98:99], v[124:125] op_sel:[0,1]
    v_pk_mul_f32 v[100:101], v[100:101], v[124:125] op_sel:[0,1]
    v_pk_mul_f32 v[102:103], v[102:103], v[124:125] op_sel:[0,1]
    v_pk_mul_f32 v[104:105], v[104:105], v[124:125] op_sel:[0,1]
    v_pk_mul_f32 v[106:107], v[106:107], v[124:125] op_sel:[0,1]
    v_pk_mul_f32 v[108:109], v[108:109], v[124:125] op_sel:[0,1]
    v_pk_mul_f32 v[110:111], v[110:111], v[124:125] op_sel:[0,1]
    v_pk_mul_f32 v[112:113], v[112:113], v[124:125] op_sel:[0,1]
    v_pk_mul_f32 v[114:115], v[114:115], v[124:125] op_sel:[0,1]
    v_cvt_pk_bf16_f32 v36, v76, v77
    v_cvt_pk_bf16_f32 v37, v78, v79
    v_cvt_pk_bf16_f32 v38, v80, v81
    v_cvt_pk_bf16_f32 v39, v82, v83
    v_cvt_pk_bf16_f32 v40, v84, v85
    v_cvt_pk_bf16_f32 v41, v86, v87
    v_cvt_pk_bf16_f32 v42, v88, v89
    v_cvt_pk_bf16_f32 v43, v90, v91
    v_cvt_pk_bf16_f32 v44, v92, v93
    v_cvt_pk_bf16_f32 v45, v94, v95
    v_cvt_pk_bf16_f32 v46, v96, v97
    v_cvt_pk_bf16_f32 v47, v98, v99
    v_cvt_pk_bf16_f32 v48, v100, v101
    v_cvt_pk_bf16_f32 v49, v102, v103
    v_cvt_pk_bf16_f32 v50, v104, v105
    v_cvt_pk_bf16_f32 v51, v106, v107
    v_cvt_pk_bf16_f32 v52, v108, v109
    v_cvt_pk_bf16_f32 v53, v110, v111
    v_cvt_pk_bf16_f32 v54, v112, v113
    v_cvt_pk_bf16_f32 v55, v114, v115
    v_mov_b32 v120, 0
    v_mov_b32 v121, 0
    v_dot2c_f32_bf16 v120, v36, v56
    v_dot2c_f32_bf16 v121, v37, v57
    v_dot2c_f32_bf16 v120, v38, v58
    v_dot2c_f32_bf16 v121, v39, v59
    v_dot2c_f32_bf16 v120, v40, v60
    v_dot2c_f32_bf16 v121, v41, v61
    v_dot2c_f32_bf16 v120, v42, v62
    v_dot2c_f32_bf16 v121, v43, v63
    v_dot2c_f32_bf16 v120, v44, v64
    v_dot2c_f32_bf16 v121, v45, v65
    v_dot2c_f32_bf16 v120, v46, v66
    v_dot2c_f32_bf16 v121, v47, v67
    v_dot2c_f32_bf16 v120, v48, v68
    v_dot2c_f32_bf16 v121, v49, v69
    v_dot2c_f32_bf16 v120, v50, v70
    v_dot2c_f32_bf16 v121, v51, v71
    v_dot2c_f32_bf16 v120, v52, v72
    v_dot2c_f32_bf16 v121, v53, v73
    v_dot2c_f32_bf16 v120, v54, v74
    v_dot2c_f32_bf16 v121, v55, v75
    s_nop 2
    v_add_f32 v120, v120, v121
    s_nop 1
    v_add_f32_dpp v120, v120, v120 quad_perm:[1,0,3,2] row_mask:0xf bank_mask:0xf
    s_nop 1
    v_add_f32_dpp v120, v120, v120 quad_perm:[2,3,0,1] row_mask:0xf bank_mask:0xf
    s_nop 1
    v_add_f32_dpp v120, v120, v120 row_half_mirror row_mask:0xf bank_mask:0xf
    s_nop 1
    v_add_f32_dpp v120, v120, v120 row_mirror row_mask:0xf bank_mask:0xf
    v_cvt_pk_bf16_f32 v120, v120, v120
    v_ashrrev_i32 v121, 31, v120
    v_or_b32 v121, 0x80000000, v121
    v_xor_b32 v120, v120, v121
    v_add_u32 v121, s55, v3
    v_add_u32 v121, 4, v121
    v_bfi_b32 v15, s7, v120, v121
    s_mov_b64 exec, s[52:53]
    buffer_store_dwordx2 v[12:13], v9, s[16:19], s57 offen offset:32 sc1
    s_mov_b64 exec, -1
    v_max_u32 v16, v14, v15
    v_min_u32 v18, v14, v15
    v_mov_b32 v20, v16
    v_mov_b32 v21, v18
    s_nop 0
    v_permlane32_swap_b32 v16, v20
    v_permlane32_swap_b32 v18, v21
    v_min_u32 v22, v16, v20
    v_max_u32 v16, v16, v20
    v_max3_u32 v18, v18, v21, v22
    v_mov_b32 v20, v16
    v_mov_b32 v21, v18
    s_nop 0
    v_permlane16_swap_b32 v16, v20
    v_permlane16_swap_b32 v18, v21
    v_min_u32 v22, v16, v20
    v_max_u32 v16, v16, v20
    v_max3_u32 v18, v18, v21, v22
    v_mov_b32 v17, s60
    v_mov_b32 v19, s60
    s_lshl_b32 s57, s55, 1
    s_add_u32 s57, s57, 0x8000
    s_mov_b64 exec, 1
    buffer_store_dwordx4 v[16:19], off, s[16:19], s57 sc1
    s_mov_b64 exec, -1
    s_setprio 0
    s_branch K_rpd
K_norp:
    s_waitcnt lgkmcnt(0)
    s_add_u32 s48, s84, 0x18000
    s_addc_u32 s49, s85, 0
    s_load_dword s60, s[48:49], 0
    s_mov_b32 s16, s84
    s_and_b32 s17, s85, 0xffff
    s_mov_b32 s18, 0x10000000
    s_mov_b32 s19, 0x20000
    s_waitcnt lgkmcnt(0)
    s_mul_i32 s60, s60, 1664525
    s_add_u32 s60, s60, 1013904223
    v_mov_b32 v16, s60
    s_lshl_b32 s48, s4, 2
    s_add_u32 s48, s48, s3
    s_lshl_b32 s48, s48, 2
    s_add_u32 s48, s48, 0x1a270
    s_mov_b64 exec, 1
    buffer_store_dword v16, off, s[16:19], s48 sc1
    s_mov_b64 exec, -1
K_rpd:
    s_cmp_ge_u32 s5, 27
    s_cbranch_scc1 K_end
    s_barrier
    s_mul_i32 s6, s4, 27
    s_add_u32 s6, s6, s5
    s_mul_i32 s61, s6, 205
    s_lshr_b32 s61, s61, 10
    s_mul_i32 s62, s61, 5
    s_sub_u32 s62, s6, s62
    s_cmp_lt_u32 s6, 215
    s_cselect_b32 s63, 1, 0
    s_cmp_lt_u32 s5, 27
    s_cselect_b32 s63, s63, 0
    s_and_b32 s40, s3, 3
    s_mul_i32 s42, s61, 48
    s_lshl_b32 s43, s62, 8
    s_lshl_b32 s6, s40, 6
    s_add_u32 s43, s43, s6
    s_cmp_eq_u32 s63, 0
    s_cbranch_scc1 K_end
    s_mov_b32 s24, s80
    s_and_b32 s25, s81, 0xffff
    s_mov_b32 s26, 0x280000
    s_mov_b32 s27, 0x20000
    v_and_b32_e64 v20, 1, v3
    v_lshl_add_u32 v20, v20, 2, v4
    v_lshl_add_u32 v20, v20, 2, v5
    s_lshl_b32 s51, s40, 3
    v_add_u32 v10, s51, v20
    v_add_u32 v11, 4, v10
    v_and_b32 v10, 31, v10
    v_and_b32 v11, 31, v11
    v_lshl_add_u32 v20, v3, 3, v4
    v_lshlrev_b32 v20, 8, v20
    v_lshl_add_u32 v10, v10, 3, v20
    v_lshl_add_u32 v11, v11, 3, v20
    v_add_u32 v1, s42, v6
    v_and_b32 v20, 1, v3
    v_lshlrev_b32 v20, 5, v20
    v_lshrrev_b32 v21, 1, v3
    v_lshl_add_u32 v20, v21, 4, v20
    v_add_u32 v20, s43, v20
    v_mov_b32 v23, 0x80000000
    s_movk_i32 s51, 1280
    v_add_u32 v21, 0, v1
    v_cmp_gt_u32 vcc, 2048, v21
    v_lshrrev_b32 v22, 10, v21
    v_and_b32 v21, 1023, v21
    v_lshl_add_u32 v21, v21, 1, v22
    v_mad_u32_u24 v21, v21, s51, v20
    v_cndmask_b32 v7, v23, v21, vcc
    v_add_u32 v21, 16, v1
    v_cmp_gt_u32 vcc, 2048, v21
    v_lshrrev_b32_e64 v22, 10, v21
    v_and_b32 v21, 1023, v21
    v_lshl_add_u32 v21, v21, 1, v22
    v_mad_u32_u24 v21, v21, s51, v20
    v_cndmask_b32 v8, v23, v21, vcc
    v_add_u32 v21, 32, v1
    v_cmp_gt_u32 vcc, 2048, v21
    v_lshrrev_b32_e64 v22, 10, v21
    v_and_b32 v21, 1023, v21
    v_lshl_add_u32 v21, v21, 1, v22
    v_mad_u32_u24 v21, v21, s51, v20
    v_cndmask_b32 v9, v23, v21, vcc
    v_lshrrev_b32 v20, 1, v3
    v_mul_u32_u24 v20, 2560, v20
    v_mul_u32_u24 v21, 160, v6
    v_add_u32 v20, v20, v21
    v_and_b32 v21, 1, v3
    v_lshl_add_u32 v4, v21, 4, v20
    v_mov_b32 v16, 144384
    v_mov_b32 v17, s60
    ds_write_b32 v16, v17
    s_cmp_lg_u32 s3, 4
    s_cbranch_scc1 HC_go
    s_mov_b32 s59, 262144
HC_poll:
    s_sleep 32
    s_mov_b32 s6, 0x10000
    buffer_load_dwordx2 v[16:17], off, s[16:19], s6 sc1
    s_waitcnt vmcnt(0)
    v_cmp_ne_u32_e64 vcc, s60, v17
    s_nop 0
    s_cbranch_vccz HC_go
    s_sub_u32 s59, s59, 1
    s_cmp_lg_u32 s59, 0
    s_cbranch_scc1 HC_poll
HC_go:
    s_waitcnt lgkmcnt(0)
    s_barrier
    s_barrier
    s_branch K_p2C
K_otherL:
    s_cmp_ge_u32 s5, 29
    s_cbranch_scc1 K_ffn1
    s_waitcnt lgkmcnt(0)
    s_mov_b32 s8, s64
    s_and_b32 s9, s65, 0xffff
    s_mov_b32 s10, 0x280000
    s_mov_b32 s11, 0x20000
    s_mov_b32 s12, s66
    s_nop 0
    s_and_b32 s13, s67, 0xffff
    s_mov_b32 s14, 0x258000
    s_mov_b32 s15, 0x20000
    s_cmp_ge_u32 s5, 27
    s_cbranch_scc1 HL_fa
    s_cmp_eq_u32 s3, 3
    s_cbranch_scc1 HL_wait
    s_sub_u32 s55, s5, 20
    s_mul_i32 s55, s55, 3
    s_add_u32 s55, s55, s3
    s_cmp_ge_u32 s55, 20
    s_cbranch_scc1 HL_wait
    s_cmp_ge_u32 s55, 15
    s_cbranch_scc1 PF_xh
    s_lshl_b32 s48, s55, 6
    v_add_u32 v9, s48, v2
    v_mul_u32_u24 v10, 4370, v9
    v_lshrrev_b32 v10, 16, v10
    v_mul_u32_u24 v11, 15, v10
    v_sub_u32 v9, v9, v11
    v_mul_u32_u24 v11, 52, v9
    v_lshrrev_b32 v11, 8, v11
    v_mul_u32_u24 v10, 3840, v10
    v_mul_u32_u24 v11, 640, v11
    v_lshl_add_u32 v8, v9, 7, v10
    s_and_b32 s48, s4, 1
    s_mul_i32 s48, s48, 640
    v_add3_u32 v8, v8, v11, s48
    s_mov_b32 s50, 1
    s_branch PF_eh
PF_xh:
    s_cmp_ge_u32 s55, 20
    s_cselect_b32 s48, 20, 15
    s_cselect_b32 s49, 0, 1
    s_sub_u32 s48, s55, s48
    s_lshl_b32 s48, s48, 6
    s_xor_b32 s49, s4, s49
    s_and_b32 s49, s49, 3
    s_lshl_b32 s49, s49, 8
    s_add_u32 s48, s48, s49
    s_cmp_eq_u32 s55, 19
    s_cselect_b32 s48, 512, s48
    s_cselect_b32 s49, 15, 63
    v_and_b32 v9, s49, v2
    v_add_u32 v9, s48, v9
    v_mul_u32_u24 v9, 2560, v9
    s_mul_i32 s48, s45, 1280
    v_add_u32_e64 v8, s48, v9
    s_mov_b32 s50, 0
PF_eh:
    s_waitcnt vmcnt(0)
    s_mov_b32 s56, 2
HL_loop:
    s_waitcnt vmcnt(1)
    s_cmp_eq_u32 s50, 0
    s_cbranch_scc1 PI_xh
    s_mul_i32 s48, s56, 245760
    buffer_load_dword v31, v8, s[12:15], s48 offen
    s_branch PI_eh
PI_xh:
    s_lshl_b32 s48, s56, 7
    buffer_load_dword v31, v8, s[8:11], s48 offen
PI_eh:
    s_add_u32 s56, s56, 1
    s_cmp_lt_u32 s56, 10
    s_cbranch_scc1 HL_loop
HL_wait:
    s_barrier
    s_mul_i32 s6, s4, 27
    s_add_u32 s6, s6, s5
    s_mul_i32 s61, s6, 205
    s_lshr_b32 s61, s61, 10
    s_mul_i32 s62, s61, 5
    s_sub_u32 s62, s6, s62
    s_cmp_lt_u32 s6, 215
    s_cselect_b32 s63, 1, 0
    s_cmp_lt_u32 s5, 27
    s_cselect_b32 s63, s63, 0
    s_and_b32 s40, s3, 3
    s_mul_i32 s42, s61, 48
    s_lshl_b32 s43, s62, 8
    s_lshl_b32 s6, s40, 6
    s_add_u32 s43, s43, s6
    s_mov_b32 s20, s68
    s_and_b32 s21, s69, 0xffff
    s_mov_b32 s22, 0xc8000
    s_mov_b32 s23, 0x20000
    s_mov_b32 s16, s84
    s_nop 0
    s_and_b32 s17, s85, 0xffff
    s_mov_b32 s18, 0x10000000
    s_mov_b32 s19, 0x20000
    s_mov_b32 s24, s80
    s_nop 0
    s_and_b32 s25, s81, 0xffff
    s_mov_b32 s26, 0x280000
    s_mov_b32 s27, 0x20000
    s_lshr_b32 s48, s3, 1
    s_lshl_b32 s48, s48, 2
    v_add_u32 v50, s48, v3
    v_lshlrev_b32 v50, 1, v50
    v_sub_u32 v50, v2, v50
    v_and_b32 v50, 15, v50
    s_lshl_b32 s48, s3, 2
    v_add_u32 v51, s48, v3
    v_mul_u32_u24 v51, 1280, v51
    v_lshl_add_u32 v51, v50, 4, v51
    s_lshl_b32 s48, s62, 8
    v_add_u32 v133, s48, v51
    s_lshl_b32 s58, s3, 10
    s_add_u32 s48, s61, 0
    s_and_b32 s48, s48, 3
    s_mul_i32 s28, s48, 204800
    s_add_u32 s48, s61, 1
    s_and_b32 s48, s48, 3
    s_mul_i32 s29, s48, 204800
    s_add_u32 s48, s61, 2
    s_and_b32 s48, s48, 3
    s_mul_i32 s30, s48, 204800
    s_add_u32 s48, s61, 3
    s_and_b32 s48, s48, 3
    s_nop 0
    s_mul_i32 s31, s48, 204800
    s_mul_i32 s49, s3, 5120
    v_lshl_add_u32 v145, v2, 4, s49
    v_add_u32 v1, s42, v6
    v_and_b32 v20, 1, v3
    v_lshlrev_b32 v20, 5, v20
    v_lshrrev_b32 v21, 1, v3
    v_lshl_add_u32 v20, v21, 4, v20
    v_add_u32 v20, s43, v20
    v_mov_b32 v23, 0x80000000
    s_movk_i32 s51, 1280
    v_add_u32 v21, 0, v1
    v_cmp_gt_u32 vcc, 2048, v21
    v_lshrrev_b32 v22, 10, v21
    v_and_b32 v21, 1023, v21
    v_lshl_add_u32 v21, v21, 1, v22
    v_mad_u32_u24 v21, v21, s51, v20
    v_cndmask_b32 v7, v23, v21, vcc
    v_add_u32 v21, 16, v1
    v_cmp_gt_u32 vcc, 2048, v21
    v_lshrrev_b32_e64 v22, 10, v21
    v_and_b32 v21, 1023, v21
    v_lshl_add_u32 v21, v21, 1, v22
    v_mad_u32_u24 v21, v21, s51, v20
    v_cndmask_b32 v8, v23, v21, vcc
    v_add_u32 v21, 32, v1
    v_cmp_gt_u32 vcc, 2048, v21
    v_lshrrev_b32_e64 v22, 10, v21
    v_and_b32 v21, 1023, v21
    v_lshl_add_u32 v21, v21, 1, v22
    v_mad_u32_u24 v21, v21, s51, v20
    v_cndmask_b32 v9, v23, v21, vcc
    s_mov_b32 s50, s42
    s_add_u32 s51, s50, 47
    s_min_u32 s51, s51, 2047
    s_lshr_b32 s6, s50, 10
    s_mul_i32 s6, s6, 10
    s_and_b32 s50, s50, 1023
    s_mul_i32 s50, s50, 2521
    s_lshr_b32 s50, s50, 18
    s_add_u32 s50, s50, s6
    s_lshr_b32 s6, s51, 10
    s_mul_i32 s6, s6, 10
    s_and_b32 s51, s51, 1023
    s_mul_i32 s51, s51, 2521
    s_lshr_b32 s51, s51, 18
    s_add_u32 s51, s51, s6
    s_sub_u32 s51, s51, s50
    s_lshl_b32 s51, s51, 10
    v_bfe_u32 v50, v2, 2, 1
    v_mul_u32_u24 v50, s51, v50
    v_bfe_u32 v51, v2, 3, 1
    v_lshl_add_u32 v50, v51, 7, v50
    s_lshl_b32 s50, s50, 2
    s_add_u32 s50, s50, s3
    s_lshl_b32 s50, s50, 8
    s_add_u32 s50, s50, 0x60000
    s_mul_i32 s51, s62, 24576
    s_add_u32 s50, s50, s51
    v_add_u32_e64 v138, s50, v50
    s_mul_i32 s50, s3, 655360
    s_mul_i32 s51, s61, 7680
    s_add_u32 s50, s50, s51
    s_nop 0
    s_add_u32 s50, s50, 0x100000
    v_lshl_add_u32 v140, v2, 4, s50
    v_add_u32 v141, 1024, v140
    v_add_u32 v50, 2048, v140
    v_add_u32 v51, 0x4fe00, v140
    v_cmp_gt_u32 vcc, 32, v2
    s_nop 1
    v_cndmask_b32_e64 v142, v51, v50, vcc
    v_add_u32 v143, 0x50200, v140
    v_add_u32 v144, 0x50600, v140
    s_lshl_b32 s50, s3, 2
    v_add_u32 v50, s50, v3
    v_xor_b32 v51, v50, v2
    v_and_b32 v51, 15, v51
    s_lshl_b32 s50, s62, 8
    v_lshl_add_u32 v51, v51, 4, s50
    v_add_u32 v50, s42, v50
    s_movk_i32 s51, 1280
    v_add_u32 v52, 0, v50
    v_min_u32 v52, 2047, v52
    v_lshrrev_b32_e64 v54, 10, v52
    v_and_b32 v52, 1023, v52
    v_lshl_add_u32 v52, v52, 1, v54
    v_mad_u32_u24 v134, v52, s51, v51
    v_add_u32 v52, 16, v50
    v_min_u32 v52, 2047, v52
    v_lshrrev_b32 v54, 10, v52
    v_and_b32 v52, 1023, v52
    v_lshl_add_u32 v52, v52, 1, v54
    v_mad_u32_u24 v135, v52, s51, v51
    v_add_u32 v52, 32, v50
    v_min_u32 v52, 2047, v52
    v_lshrrev_b32 v54, 10, v52
    v_and_b32 v52, 1023, v52
    v_lshl_add_u32 v52, v52, 1, v54
    v_mad_u32_u24 v136, v52, s51, v51
    s_lshl_b32 s50, s42, 3
    s_nop 0
    v_lshl_add_u32 v137, v2, 4, s50
    s_add_u32 m0, s58, 98304
    s_add_u32 s48, s30, 40960
    buffer_load_dwordx4 v133, s[20:23], s48 offen lds
    s_add_u32 m0, s58, 102400
    s_add_u32 s48, s30, 143360
    buffer_load_dwordx4 v133, s[20:23], s48 offen lds
    s_add_u32 m0, s58, 106496
    s_add_u32 s48, s30, 61440
    buffer_load_dwordx4 v133, s[20:23], s48 offen lds
    s_add_u32 m0, s58, 110592
    s_add_u32 s48, s30, 163840
    buffer_load_dwordx4 v133, s[20:23], s48 offen lds
    s_add_u32 m0, s58, 114688
    s_add_u32 s48, s30, 81920
    buffer_load_dwordx4 v133, s[20:23], s48 offen lds
    s_add_u32 m0, s58, 118784
    s_add_u32 s48, s30, 184320
    buffer_load_dwordx4 v133, s[20:23], s48 offen lds
    s_add_u32 m0, s58, 0
    s_add_u32 s48, s28, 0
    buffer_load_dwordx4 v133, s[20:23], s48 offen lds
    s_add_u32 m0, s58, 4096
    s_add_u32 s48, s28, 102400
    buffer_load_dwordx4 v133, s[20:23], s48 offen lds
    s_add_u32 m0, s58, 8192
    s_add_u32 s48, s28, 20480
    buffer_load_dwordx4 v133, s[20:23], s48 offen lds
    s_add_u32 m0, s58, 12288
    s_add_u32 s48, s28, 122880
    buffer_load_dwordx4 v133, s[20:23], s48 offen lds
    s_add_u32 m0, s58, 16384
    s_add_u32 s48, s28, 40960
    buffer_load_dwordx4 v133, s[20:23], s48 offen lds
    s_add_u32 m0, s58, 20480
    s_add_u32 s48, s28, 143360
    buffer_load_dwordx4 v133, s[20:23], s48 offen lds
    s_add_u32 m0, s58, 24576
    s_add_u32 s48, s28, 61440
    buffer_load_dwordx4 v133, s[20:23], s48 offen lds
    s_add_u32 m0, s58, 28672
    s_add_u32 s48, s28, 163840
    buffer_load_dwordx4 v133, s[20:23], s48 offen lds
    s_add_u32 m0, s58, 32768
    s_add_u32 s48, s28, 81920
    buffer_load_dwordx4 v133, s[20:23], s48 offen lds
    s_add_u32 m0, s58, 36864
    s_add_u32 s48, s28, 184320
    buffer_load_dwordx4 v133, s[20:23], s48 offen lds
    s_add_u32 m0, s58, 40960
    s_add_u32 s48, s29, 0
    s_nop 0
    buffer_load_dwordx4 v133, s[20:23], s48 offen lds
    s_add_u32 m0, s58, 45056
    s_add_u32 s48, s29, 102400
    buffer_load_dwordx4 v133, s[20:23], s48 offen lds
    s_add_u32 m0, s58, 49152
    s_add_u32 s48, s29, 20480
    buffer_load_dwordx4 v133, s[20:23], s48 offen lds
    s_add_u32 m0, s58, 53248
    s_add_u32 s48, s29, 122880
    buffer_load_dwordx4 v133, s[20:23], s48 offen lds
    s_add_u32 m0, s58, 57344
    s_add_u32 s48, s29, 40960
    buffer_load_dwordx4 v133, s[20:23], s48 offen lds
    s_add_u32 m0, s58, 61440
    s_add_u32 s48, s29, 143360
    buffer_load_dwordx4 v133, s[20:23], s48 offen lds
    s_add_u32 m0, s58, 65536
    s_add_u32 s48, s29, 61440
    buffer_load_dwordx4 v133, s[20:23], s48 offen lds
    s_add_u32 m0, s58, 69632
    s_add_u32 s48, s29, 163840
    buffer_load_dwordx4 v133, s[20:23], s48 offen lds
    s_add_u32 m0, s58, 73728
    s_add_u32 s48, s29, 81920
    buffer_load_dwordx4 v133, s[20:23], s48 offen lds
    s_add_u32 m0, s58, 77824
    s_add_u32 s48, s29, 184320
    buffer_load_dwordx4 v133, s[20:23], s48 offen lds
    s_add_u32 m0, s58, 81920
    s_add_u32 s48, s30, 0
    s_nop 0
    buffer_load_dwordx4 v133, s[20:23], s48 offen lds
    s_add_u32 m0, s58, 86016
    s_add_u32 s48, s30, 102400
    buffer_load_dwordx4 v133, s[20:23], s48 offen lds
    s_add_u32 m0, s58, 90112
    s_add_u32 s48, s30, 20480
    buffer_load_dwordx4 v133, s[20:23], s48 offen lds
    s_add_u32 m0, s58, 94208
    s_add_u32 s48, s30, 122880
    buffer_load_dwordx4 v133, s[20:23], s48 offen lds
    s_add_u32 s48, s31, 0
    s_nop 0
    buffer_load_dwordx4 v[64:67], v133, s[20:23], s48 offen
    s_add_u32 s48, s31, 102400
    buffer_load_dwordx4 v[68:71], v133, s[20:23], s48 offen
    s_add_u32 s48, s31, 20480
    buffer_load_dwordx4 v[72:75], v133, s[20:23], s48 offen
    s_add_u32 s48, s31, 122880
    buffer_load_dwordx4 v[76:79], v133, s[20:23], s48 offen
    s_add_u32 s48, s31, 40960
    buffer_load_dwordx4 v[80:83], v133, s[20:23], s48 offen
    s_add_u32 s48, s31, 143360
    buffer_load_dwordx4 v[84:87], v133, s[20:23], s48 offen
    s_add_u32 s48, s31, 61440
    buffer_load_dwordx4 v[88:91], v133, s[20:23], s48 offen
    s_add_u32 s48, s31, 163840
    buffer_load_dwordx4 v[92:95], v133, s[20:23], s48 offen
    s_add_u32 s48, s31, 81920
    buffer_load_dwordx4 v[96:99], v133, s[20:23], s48 offen
    s_add_u32 s48, s31, 184320
    buffer_load_dwordx4 v[100:103], v133, s[20:23], s48 offen
    s_cmp_eq_u32 s63, 0
    s_cbranch_scc1 K_end
    s_barrier
    s_lshl_b32 s48, s3, 10
    s_add_u32 m0, s48, 145408
    s_nop 0
    buffer_load_dwordx4 v134, s[8:11], 0 offen lds
    s_add_u32 m0, s48, 149504
    s_nop 0
    buffer_load_dwordx4 v135, s[8:11], 0 offen lds
    s_add_u32 m0, s48, 153600
    s_nop 0
    s_nop 0
    buffer_load_dwordx4 v136, s[8:11], 0 offen lds
    s_mov_b32 m0, 157696
    s_mov_b64 exec, 0xffffff
    buffer_load_dwordx4 v137, s[16:19], 0 offen sc1 lds
    s_mov_b32 m0, 158080
    s_mov_b64 exec, 1
    s_mov_b32 s48, 0x10000
    buffer_load_dwordx4 off, s[16:19], s48 sc1 lds
    s_mov_b64 exec, -1
    v_mov_b32 v50, 144384
    ds_read_b32 v50, v50
    s_waitcnt vmcnt(0) lgkmcnt(0)
    v_readfirstlane_b32 s60, v50
    s_barrier
    s_branch K_p2L
P1C_slow:
    s_lshl_b32 s51, s45, 10
    s_movk_i32 s52, 1023
    s_mov_b32 s59, 262144
P1C_poll:
    s_add_u32 s53, s46, -8
    v_add_u32 v152, s53, v6
    v_med3_i32 v152, v152, 0, s52
    v_add_lshl_u32 v152, v152, s51, 3
    buffer_load_dwordx2 v[216:217], v152, s[16:19], 0 offen sc1
    s_add_u32 s53, s46, 8
    v_add_u32 v152, s53, v6
    v_med3_i32 v152, v152, 0, s52
    v_add_lshl_u32 v152, v152, s51, 3
    buffer_load_dwordx2 v[218:219], v152, s[16:19], 0 offen sc1
    s_add_u32 s53, s46, 24
    v_add_u32 v152, s53, v6
    v_med3_i32 v152, v152, 0, s52
    v_add_lshl_u32 v152, v152, s51, 3
    buffer_load_dwordx2 v[220:221], v152, s[16:19], 0 offen sc1
    s_add_u32 s53, s46, 40
    v_add_u32 v152, s53, v6
    v_med3_i32 v152, v152, 0, s52
    v_add_lshl_u32 v152, v152, s51, 3
    buffer_load_dwordx2 v[250:251], v152, s[16:19], 0 offen sc1
    s_add_u32 s53, s46, 56
    v_add_u32 v152, s53, v6
    v_med3_i32 v152, v152, 0, s52
    v_add_lshl_u32 v152, v152, s51, 3
    buffer_load_dwordx2 v[252:253], v152, s[16:19], 0 offen sc1
    s_add_u32 s53, s46, 72
    v_add_u32_e64 v152, s53, v6
    v_med3_i32 v152, v152, 0, s52
    v_add_lshl_u32 v152, v152, s51, 3
    buffer_load_dwordx2 v[254:255], v152, s[16:19], 0 offen sc1
    s_add_u32 s53, s46, 88
    v_add_u32_e64 v152, s53, v6
    v_med3_i32 v152, v152, 0, s52
    v_add_lshl_u32 v152, v152, s51, 3
    buffer_load_dwordx2 v[12:13], v152, s[16:19], 0 offen sc1
    s_waitcnt vmcnt(0)
    v_xor_b32 v144, s60, v217
    v_xor_b32 v145, s60, v219
    v_xor_b32 v146, s60, v221
    v_xor_b32 v147, s60, v251
    v_xor_b32 v148, s60, v253
    v_xor_b32 v149, s60, v255
    v_xor_b32 v150, s60, v13
    v_or3_b32 v144, v144, v145, v146
    v_or3_b32 v147, v147, v148, v149
    v_or3_b32 v144, v144, v147, v150
    v_cmp_ne_u32 vcc, 0, v144
    s_nop 0
    s_cbranch_vccz P1C_statok
    s_sub_u32 s59, s59, 1
    s_cmp_lg_u32 s59, 0
    s_cbranch_scc1 P1C_poll
    s_branch P1C_statok
HL_fa:
    s_mov_b32 s36, s74
    s_and_b32 s37, s75, 0xffff
    s_mov_b32 s38, 0x1e0000
    s_mov_b32 s39, 0x20000
    s_mov_b32 s28, s76
    s_nop 0
    s_and_b32 s29, s77, 0xffff
    s_mov_b32 s30, 0x1e0000
    s_mov_b32 s31, 0x20000
    s_mov_b32 s20, s78
    s_nop 0
    s_and_b32 s21, s79, 0xffff
    s_mov_b32 s22, 0x1e0000
    s_mov_b32 s23, 0x20000
    s_sub_u32 s55, s5, 27
    s_lshl_b32 s55, s55, 2
    s_add_u32 s55, s55, s3
    s_mul_i32 s49, s4, 384
    s_lshl_b32 s48, s55, 6
    s_add_u32 s48, s48, 0
    v_add_u32 v9, s48, v2
    v_mul_u32_u24 v10, 21846, v9
    v_lshrrev_b32 v10, 16, v10
    v_mul_u32_u24 v11, 3, v10
    v_sub_u32 v9, v9, v11
    v_and_b32 v11, 3, v10
    v_lshrrev_b32_e64 v10, 2, v10
    v_sub_u32 v10, 159, v10
    v_mul_u32_u24 v11, 160, v11
    v_add_u32_e64 v10, v10, v11
    v_mul_u32_u24 v10, 3072, v10
    v_lshl_add_u32 v10, v9, 7, v10
    s_waitcnt vmcnt(0)
    buffer_load_dword v31, v10, s[36:39], s49 offen
    s_waitcnt vmcnt(0)
    buffer_load_dword v31, v10, s[28:31], s49 offen
    s_lshl_b32 s48, s55, 6
    s_add_u32 s48, s48, 512
    v_add_u32 v9, s48, v2
    v_mul_u32_u24 v10, 21846, v9
    v_lshrrev_b32 v10, 16, v10
    v_mul_u32_u24 v11, 3, v10
    v_sub_u32 v9, v9, v11
    v_and_b32 v11, 3, v10
    v_lshrrev_b32_e64 v10, 2, v10
    v_sub_u32 v10, 159, v10
    v_mul_u32_u24 v11, 160, v11
    v_add_u32_e64 v10, v10, v11
    v_mul_u32_u24 v10, 3072, v10
    v_lshl_add_u32 v10, v9, 7, v10
    s_waitcnt vmcnt(0)
    buffer_load_dword v31, v10, s[36:39], s49 offen
    s_waitcnt vmcnt(0)
    buffer_load_dword v31, v10, s[28:31], s49 offen
    v_lshlrev_b32 v10, 7, v2
    s_mul_i32 s48, s4, 245760
    s_lshl_b32 s49, s55, 13
    s_add_u32 s48, s48, s49
    s_waitcnt vmcnt(0)
    buffer_load_dword v31, v10, s[20:23], s48 offen
    s_add_u32 s48, s48, 65536
    s_waitcnt vmcnt(0)
    buffer_load_dword v31, v10, s[20:23], s48 offen
    s_add_u32 s48, s48, 65536
    s_waitcnt vmcnt(0)
    buffer_load_dword v31, v10, s[20:23], s48 offen
    s_add_u32 s48, s48, 49152
    s_waitcnt vmcnt(0)
    buffer_load_dword v31, v10, s[20:23], s48 offen
    s_add_u32 s48, s48, 49152
    s_branch K_end
UP_retry:
    s_sleep 1
    s_mov_b32 s6, 0x10000
    buffer_load_dwordx2 v[44:45], off, s[16:19], s6 sc1
    s_lshl_b32 s6, s43, 1
    s_add_u32 s6, s6, 0x1c000
    buffer_load_dwordx4 v[168:171], v54, s[16:19], s6 offen offset:0 sc1
    buffer_load_dwordx4 v[172:175], v54, s[16:19], s6 offen offset:16 sc1
    buffer_load_dwordx4 v[176:179], v54, s[16:19], s6 offen offset:2560 sc1
    buffer_load_dwordx4 v[180:183], v54, s[16:19], s6 offen offset:2576 sc1
    s_waitcnt vmcnt(0)
    s_sub_u32 s59, s59, 1
    s_cmp_lg_u32 s59, 0
    s_cbranch_scc1 UP_p
    s_branch UP_ok
K_ffn1:
    s_sub_u32 s44, s5, 29
    s_mul_i32 s46, s4, 3
    s_add_u32 s44, s44, s46
    s_mov_b32 s46, 0x05040100
    s_mov_b32 s47, 0x07060302
    s_waitcnt lgkmcnt(0)
    v_cmp_gt_u32 vcc, 8, v6
    v_mov_b32 v8, s76
    v_mov_b32 v9, s77
    v_mov_b32 v10, s74
    v_mov_b32 v11, s75
    v_cndmask_b32 v8, v8, v10, vcc
    v_cndmask_b32 v9, v9, v11, vcc
    s_mul_i32 s48, s3, 160
    v_add_u32 v10, s48, v3
    v_mul_u32_u24 v10, 3072, v10
    v_and_b32 v11, 7, v6
    v_lshl_add_u32 v10, v11, 4, v10
    s_lshl_b32 s48, s44, 7
    v_add_u32 v10, s48, v10
    v_add_co_u32 v8, vcc, v8, v10
    s_nop 1
    v_addc_co_u32_e64 v9, vcc, 0, v9, vcc
    global_load_dwordx4 v[64:67], v[8:9], off
    v_add_co_u32 v8, vcc, 0x3000, v8
    s_nop 1
    v_addc_co_u32 v9, vcc, 0, v9, vcc
    global_load_dwordx4 v[68:71], v[8:9], off
    v_add_co_u32 v8, vcc, 0x3000, v8
    s_nop 1
    v_addc_co_u32 v9, vcc, 0, v9, vcc
    global_load_dwordx4 v[72:75], v[8:9], off
    v_add_co_u32 v8, vcc, 0x3000, v8
    s_nop 1
    v_addc_co_u32 v9, vcc, 0, v9, vcc
    global_load_dwordx4 v[76:79], v[8:9], off
    v_add_co_u32 v8, vcc, 0x3000, v8
    s_nop 1
    v_addc_co_u32 v9, vcc, 0, v9, vcc
    global_load_dwordx4 v[80:83], v[8:9], off
    v_add_co_u32 v8, vcc, 0x3000, v8
    s_nop 1
    v_addc_co_u32 v9, vcc, 0, v9, vcc
    global_load_dwordx4 v[84:87], v[8:9], off
    v_add_co_u32 v8, vcc, 0x3000, v8
    s_nop 1
    v_addc_co_u32 v9, vcc, 0, v9, vcc
    global_load_dwordx4 v[88:91], v[8:9], off
    v_add_co_u32 v8, vcc, 0x3000, v8
    s_nop 1
    v_addc_co_u32 v9, vcc, 0, v9, vcc
    global_load_dwordx4 v[92:95], v[8:9], off
    v_add_co_u32 v8, vcc, 0x3000, v8
    s_nop 1
    v_addc_co_u32 v9, vcc, 0, v9, vcc
    global_load_dwordx4 v[96:99], v[8:9], off
    v_add_co_u32 v8, vcc, 0x3000, v8
    s_nop 1
    v_addc_co_u32 v9, vcc, 0, v9, vcc
    global_load_dwordx4 v[100:103], v[8:9], off
    v_add_co_u32 v8, vcc, 0x3000, v8
    s_nop 1
    v_addc_co_u32 v9, vcc, 0, v9, vcc
    global_load_dwordx4 v[104:107], v[8:9], off
    v_add_co_u32 v8, vcc, 0x3000, v8
    s_nop 1
    v_addc_co_u32 v9, vcc, 0, v9, vcc
    global_load_dwordx4 v[108:111], v[8:9], off
    v_add_co_u32 v8, vcc, 0x3000, v8
    s_nop 1
    v_addc_co_u32 v9, vcc, 0, v9, vcc
    global_load_dwordx4 v[112:115], v[8:9], off
    v_add_co_u32 v8, vcc, 0x3000, v8
    s_nop 1
    v_addc_co_u32 v9, vcc, 0, v9, vcc
    global_load_dwordx4 v[116:119], v[8:9], off
    v_add_co_u32 v8, vcc, 0x3000, v8
    s_nop 1
    v_addc_co_u32 v9, vcc, 0, v9, vcc
    global_load_dwordx4 v[120:123], v[8:9], off
    v_add_co_u32 v8, vcc, 0x3000, v8
    s_nop 1
    v_addc_co_u32 v9, vcc, 0, v9, vcc
    global_load_dwordx4 v[124:127], v[8:9], off
    v_add_co_u32 v8, vcc, 0x3000, v8
    s_nop 1
    v_addc_co_u32 v9, vcc, 0, v9, vcc
    global_load_dwordx4 v[128:131], v[8:9], off
    v_add_co_u32 v8, vcc, 0x3000, v8
    s_nop 1
    v_addc_co_u32 v9, vcc, 0, v9, vcc
    global_load_dwordx4 v[132:135], v[8:9], off
    v_add_co_u32 v8, vcc, 0x3000, v8
    s_nop 1
    v_addc_co_u32 v9, vcc, 0, v9, vcc
    global_load_dwordx4 v[136:139], v[8:9], off
    v_add_co_u32 v8, vcc, 0x3000, v8
    s_nop 1
    v_addc_co_u32 v9, vcc, 0, v9, vcc
    global_load_dwordx4 v[140:143], v[8:9], off
    v_add_co_u32 v8, vcc, 0x3000, v8
    s_nop 1
    v_addc_co_u32 v9, vcc, 0, v9, vcc
    global_load_dwordx4 v[144:147], v[8:9], off
    v_add_co_u32 v8, vcc, 0x3000, v8
    s_nop 1
    v_addc_co_u32 v9, vcc, 0, v9, vcc
    global_load_dwordx4 v[148:151], v[8:9], off
    v_add_co_u32 v8, vcc, 0x3000, v8
    s_nop 1
    v_addc_co_u32 v9, vcc, 0, v9, vcc
    global_load_dwordx4 v[152:155], v[8:9], off
    v_add_co_u32 v8, vcc, 0x3000, v8
    s_nop 1
    v_addc_co_u32 v9, vcc, 0, v9, vcc
    global_load_dwordx4 v[156:159], v[8:9], off
    v_add_co_u32 v8, vcc, 0x3000, v8
    s_nop 1
    v_addc_co_u32 v9, vcc, 0, v9, vcc
    global_load_dwordx4 v[160:163], v[8:9], off
    v_add_co_u32 v8, vcc, 0x3000, v8
    s_nop 1
    v_addc_co_u32 v9, vcc, 0, v9, vcc
    global_load_dwordx4 v[164:167], v[8:9], off
    v_add_co_u32 v8, vcc, 0x3000, v8
    s_nop 1
    v_addc_co_u32 v9, vcc, 0, v9, vcc
    global_load_dwordx4 v[168:171], v[8:9], off
    v_add_co_u32 v8, vcc, 0x3000, v8
    s_nop 1
    v_addc_co_u32 v9, vcc, 0, v9, vcc
    global_load_dwordx4 v[172:175], v[8:9], off
    v_add_co_u32 v8, vcc, 0x3000, v8
    s_nop 1
    v_addc_co_u32 v9, vcc, 0, v9, vcc
    global_load_dwordx4 v[176:179], v[8:9], off
    v_add_co_u32 v8, vcc, 0x3000, v8
    s_nop 1
    v_addc_co_u32 v9, vcc, 0, v9, vcc
    global_load_dwordx4 v[180:183], v[8:9], off
    v_add_co_u32 v8, vcc, 0x3000, v8
    s_nop 1
    v_addc_co_u32 v9, vcc, 0, v9, vcc
    global_load_dwordx4 v[184:187], v[8:9], off
    v_add_co_u32 v8, vcc, 0x3000, v8
    s_nop 1
    v_addc_co_u32 v9, vcc, 0, v9, vcc
    global_load_dwordx4 v[188:191], v[8:9], off
    v_add_co_u32 v8, vcc, 0x3000, v8
    s_nop 1
    v_addc_co_u32 v9, vcc, 0, v9, vcc
    global_load_dwordx4 v[192:195], v[8:9], off
    v_add_co_u32 v8, vcc, 0x3000, v8
    s_nop 1
    v_addc_co_u32 v9, vcc, 0, v9, vcc
    global_load_dwordx4 v[196:199], v[8:9], off
    v_add_co_u32 v8, vcc, 0x3000, v8
    s_nop 1
    v_addc_co_u32 v9, vcc, 0, v9, vcc
    global_load_dwordx4 v[200:203], v[8:9], off
    v_add_co_u32 v8, vcc, 0x3000, v8
    s_nop 1
    v_addc_co_u32 v9, vcc, 0, v9, vcc
    global_load_dwordx4 v[204:207], v[8:9], off
    v_add_co_u32 v8, vcc, 0x3000, v8
    s_nop 1
    v_addc_co_u32 v9, vcc, 0, v9, vcc
    global_load_dwordx4 v[208:211], v[8:9], off
    v_add_co_u32 v8, vcc, 0x3000, v8
    s_nop 1
    v_addc_co_u32 v9, vcc, 0, v9, vcc
    global_load_dwordx4 v[212:215], v[8:9], off
    v_add_co_u32 v8, vcc, 0x3000, v8
    s_nop 1
    v_addc_co_u32 v9, vcc, 0, v9, vcc
    global_load_dwordx4 v[216:219], v[8:9], off
    v_add_co_u32 v8, vcc, 0x3000, v8
    s_nop 1
    v_addc_co_u32 v9, vcc, 0, v9, vcc
    global_load_dwordx4 v[220:223], v[8:9], off
    s_mov_b32 s16, s84
    s_nop 0
    s_and_b32 s17, s85, 0xffff
    s_mov_b32 s18, 0x10000000
    s_mov_b32 s19, 0x20000
    s_mul_i32 s50, s3, 320
    s_add_u32 s50, s50, 12288
    v_and_b32_e64 v27, 1, v2
    v_mul_u32_u24 v27, 1280, v27
    v_lshl_add_u32 v27, v3, 4, v27
    v_add_u32 v27, s50, v27
    s_lshl_b32 s50, s3, 10
    s_add_u32 s50, s50, 1024
    v_lshlrev_b32 v28, 9, v6
    v_lshl_add_u32 v28, v3, 4, v28
    v_add_u32 v28, s50, v28
    s_mov_b32 s52, 0x30003
    s_mov_b32 s53, 0x30003
    s_waitcnt vmcnt(32)
    s_cmp_lg_u32 s3, 3
    s_cbranch_scc1 FF_nk
    v_mov_b32 v8, 64
    v_mov_b32_e64 v9, 1
    ds_write_b32 v8, v9 offset:12
FF_nk:
    v_perm_b32 v32, v68, v64, s46
    v_perm_b32 v33, v76, v72, s46
    v_perm_b32 v34, v84, v80, s46
    v_perm_b32 v35, v92, v88, s46
    v_perm_b32 v36, v68, v64, s47
    v_perm_b32 v37, v76, v72, s47
    v_perm_b32 v38, v84, v80, s47
    v_perm_b32 v39, v92, v88, s47
    v_perm_b32 v40, v69, v65, s46
    v_perm_b32 v41, v77, v73, s46
    v_perm_b32 v42, v85, v81, s46
    v_perm_b32 v43, v93, v89, s46
    v_perm_b32 v44, v69, v65, s47
    v_perm_b32 v45, v77, v73, s47
    v_perm_b32 v46, v85, v81, s47
    v_perm_b32 v47, v93, v89, s47
    v_perm_b32 v48, v70, v66, s46
    v_perm_b32 v49, v78, v74, s46
    v_perm_b32 v50, v86, v82, s46
    v_perm_b32 v51, v94, v90, s46
    v_perm_b32 v52, v70, v66, s47
    v_perm_b32 v53, v78, v74, s47
    v_perm_b32 v54, v86, v82, s47
    v_perm_b32 v55, v94, v90, s47
    v_perm_b32 v56, v71, v67, s46
    v_perm_b32 v57, v79, v75, s46
    v_perm_b32 v58, v87, v83, s46
    v_perm_b32 v59, v95, v91, s46
    v_perm_b32 v60, v71, v67, s47
    v_perm_b32 v61, v79, v75, s47
    v_perm_b32 v62, v87, v83, s47
    v_perm_b32 v63, v95, v91, s47
    s_waitcnt vmcnt(24)
    s_nop 0
    v_perm_b32 v64, v100, v96, s46
    v_perm_b32 v65, v108, v104, s46
    v_perm_b32 v66, v116, v112, s46
    v_perm_b32 v67, v124, v120, s46
    v_perm_b32 v68, v100, v96, s47
    v_perm_b32 v69, v108, v104, s47
    v_perm_b32 v70, v116, v112, s47
    v_perm_b32 v71, v124, v120, s47
    v_perm_b32 v72, v101, v97, s46
    v_perm_b32 v73, v109, v105, s46
    v_perm_b32 v74, v117, v113, s46
    v_perm_b32 v75, v125, v121, s46
    v_perm_b32 v76, v101, v97, s47
    v_perm_b32 v77, v109, v105, s47
    v_perm_b32 v78, v117, v113, s47
    v_perm_b32 v79, v125, v121, s47
    v_perm_b32 v80, v102, v98, s46
    v_perm_b32 v81, v110, v106, s46
    v_perm_b32 v82, v118, v114, s46
    v_perm_b32 v83, v126, v122, s46
    v_perm_b32 v84, v102, v98, s47
    v_perm_b32 v85, v110, v106, s47
    v_perm_b32 v86, v118, v114, s47
    v_perm_b32 v87, v126, v122, s47
    v_perm_b32 v88, v103, v99, s46
    v_perm_b32 v89, v111, v107, s46
    v_perm_b32 v90, v119, v115, s46
    v_perm_b32 v91, v127, v123, s46
    v_perm_b32 v92, v103, v99, s47
    v_perm_b32 v93, v111, v107, s47
    v_perm_b32 v94, v119, v115, s47
    v_perm_b32 v95, v127, v123, s47
    s_waitcnt vmcnt(16)
    s_nop 0
    v_perm_b32 v96, v132, v128, s46
    v_perm_b32 v97, v140, v136, s46
    v_perm_b32 v98, v148, v144, s46
    v_perm_b32 v99, v156, v152, s46
    v_perm_b32 v100, v132, v128, s47
    v_perm_b32 v101, v140, v136, s47
    v_perm_b32 v102, v148, v144, s47
    v_perm_b32 v103, v156, v152, s47
    v_perm_b32 v104, v133, v129, s46
    v_perm_b32 v105, v141, v137, s46
    v_perm_b32 v106, v149, v145, s46
    v_perm_b32 v107, v157, v153, s46
    v_perm_b32 v108, v133, v129, s47
    v_perm_b32 v109, v141, v137, s47
    v_perm_b32 v110, v149, v145, s47
    v_perm_b32 v111, v157, v153, s47
    v_perm_b32 v112, v134, v130, s46
    v_perm_b32 v113, v142, v138, s46
    v_perm_b32 v114, v150, v146, s46
    v_perm_b32 v115, v158, v154, s46
    v_perm_b32 v116, v134, v130, s47
    v_perm_b32 v117, v142, v138, s47
    v_perm_b32 v118, v150, v146, s47
    v_perm_b32 v119, v158, v154, s47
    v_perm_b32 v120, v135, v131, s46
    v_perm_b32 v121, v143, v139, s46
    v_perm_b32 v122, v151, v147, s46
    v_perm_b32 v123, v159, v155, s46
    v_perm_b32 v124, v135, v131, s47
    v_perm_b32 v125, v143, v139, s47
    v_perm_b32 v126, v151, v147, s47
    v_perm_b32 v127, v159, v155, s47
    s_waitcnt vmcnt(8)
    s_nop 0
    v_perm_b32 v128, v164, v160, s46
    v_perm_b32 v129, v172, v168, s46
    v_perm_b32 v130, v180, v176, s46
    v_perm_b32 v131, v188, v184, s46
    v_perm_b32 v132, v164, v160, s47
    v_perm_b32 v133, v172, v168, s47
    v_perm_b32 v134, v180, v176, s47
    v_perm_b32 v135, v188, v184, s47
    v_perm_b32 v136, v165, v161, s46
    v_perm_b32 v137, v173, v169, s46
    v_perm_b32 v138, v181, v177, s46
    v_perm_b32 v139, v189, v185, s46
    v_perm_b32 v140, v165, v161, s47
    v_perm_b32 v141, v173, v169, s47
    v_perm_b32 v142, v181, v177, s47
    v_perm_b32 v143, v189, v185, s47
    v_perm_b32 v144, v166, v162, s46
    v_perm_b32 v145, v174, v170, s46
    v_perm_b32 v146, v182, v178, s46
    v_perm_b32 v147, v190, v186, s46
    v_perm_b32 v148, v166, v162, s47
    v_perm_b32 v149, v174, v170, s47
    v_perm_b32 v150, v182, v178, s47
    v_perm_b32 v151, v190, v186, s47
    v_perm_b32 v152, v167, v163, s46
    v_perm_b32 v153, v175, v171, s46
    v_perm_b32 v154, v183, v179, s46
    v_perm_b32 v155, v191, v187, s46
    v_perm_b32 v156, v167, v163, s47
    v_perm_b32 v157, v175, v171, s47
    v_perm_b32 v158, v183, v179, s47
    v_perm_b32 v159, v191, v187, s47
    s_waitcnt vmcnt(0)
    s_nop 0
    v_perm_b32 v160, v196, v192, s46
    v_perm_b32 v161, v204, v200, s46
    v_perm_b32 v162, v212, v208, s46
    v_perm_b32 v163, v220, v216, s46
    v_perm_b32 v164, v196, v192, s47
    v_perm_b32 v165, v204, v200, s47
    v_perm_b32 v166, v212, v208, s47
    v_perm_b32 v167, v220, v216, s47
    v_perm_b32 v168, v197, v193, s46
    v_perm_b32 v169, v205, v201, s46
    v_perm_b32 v170, v213, v209, s46
    v_perm_b32 v171, v221, v217, s46
    v_perm_b32 v172, v197, v193, s47
    v_perm_b32 v173, v205, v201, s47
    v_perm_b32 v174, v213, v209, s47
    v_perm_b32 v175, v221, v217, s47
    v_perm_b32 v176, v198, v194, s46
    v_perm_b32 v177, v206, v202, s46
    v_perm_b32 v178, v214, v210, s46
    v_perm_b32 v179, v222, v218, s46
    v_perm_b32 v180, v198, v194, s47
    v_perm_b32 v181, v206, v202, s47
    v_perm_b32 v182, v214, v210, s47
    v_perm_b32 v183, v222, v218, s47
    v_perm_b32 v184, v199, v195, s46
    v_perm_b32 v185, v207, v203, s46
    v_perm_b32 v186, v215, v211, s46
    v_perm_b32 v187, v223, v219, s46
    v_perm_b32 v188, v199, v195, s47
    v_perm_b32 v189, v207, v203, s47
    v_perm_b32 v190, v215, v211, s47
    v_perm_b32 v191, v223, v219, s47
    v_mov_b32_e64 v8, 64
    s_mov_b32 s59, 262144
FF_s1:
    ds_read_b32 v9, v8 offset:0
    s_waitcnt lgkmcnt(0)
    v_cmp_ne_u32 vcc, 1, v9
    s_nop 0
    s_cbranch_vccz FF_s1_ok
    s_sleep 1
    s_sub_u32 s59, s59, 1
    s_cmp_lg_u32 s59, 0
    s_cbranch_scc1 FF_s1
FF_s1_ok:
    s_setprio 3
    v_mov_b32 v8, 0
    ds_read_b32 v12, v8 offset:4
    ds_read_b128 v[196:199], v27 offset:0
    ds_read_b128 v[200:203], v27 offset:64
    ds_read_b128 v[204:207], v27 offset:128
    ds_read_b128 v[208:211], v27 offset:192
    ds_read_b128 v[212:215], v27 offset:256
    s_waitcnt lgkmcnt(4)
    s_nop 0
    v_mfma_f32_16x16x32_bf16 v[224:227], v[32:35], v[196:199], 0
    v_mfma_f32_16x16x32_bf16 v[228:231], v[36:39], v[196:199], 0
    v_mfma_f32_16x16x32_bf16 v[232:235], v[40:43], v[196:199], 0
    v_mfma_f32_16x16x32_bf16 v[236:239], v[44:47], v[196:199], 0
    v_mfma_f32_16x16x32_bf16 v[240:243], v[48:51], v[196:199], 0
    v_mfma_f32_16x16x32_bf16 v[244:247], v[52:55], v[196:199], 0
    v_mfma_f32_16x16x32_bf16 v[248:251], v[56:59], v[196:199], 0
    v_mfma_f32_16x16x32_bf16 v[252:255], v[60:63], v[196:199], 0
    s_waitcnt lgkmcnt(3)
    s_nop 0
    v_mfma_f32_16x16x32_bf16 v[224:227], v[64:67], v[200:203], v[224:227]
    v_mfma_f32_16x16x32_bf16 v[228:231], v[68:71], v[200:203], v[228:231]
    v_mfma_f32_16x16x32_bf16 v[232:235], v[72:75], v[200:203], v[232:235]
    v_mfma_f32_16x16x32_bf16 v[236:239], v[76:79], v[200:203], v[236:239]
    v_mfma_f32_16x16x32_bf16 v[240:243], v[80:83], v[200:203], v[240:243]
    v_mfma_f32_16x16x32_bf16 v[244:247], v[84:87], v[200:203], v[244:247]
    v_mfma_f32_16x16x32_bf16 v[248:251], v[88:91], v[200:203], v[248:251]
    v_mfma_f32_16x16x32_bf16 v[252:255], v[92:95], v[200:203], v[252:255]
    s_waitcnt lgkmcnt(2)
    s_nop 0
    v_mfma_f32_16x16x32_bf16 v[224:227], v[96:99], v[204:207], v[224:227]
    v_mfma_f32_16x16x32_bf16 v[228:231], v[100:103], v[204:207], v[228:231]
    v_mfma_f32_16x16x32_bf16 v[232:235], v[104:107], v[204:207], v[232:235]
    v_mfma_f32_16x16x32_bf16 v[236:239], v[108:111], v[204:207], v[236:239]
    v_mfma_f32_16x16x32_bf16 v[240:243], v[112:115], v[204:207], v[240:243]
    v_mfma_f32_16x16x32_bf16 v[244:247], v[116:119], v[204:207], v[244:247]
    v_mfma_f32_16x16x32_bf16 v[248:251], v[120:123], v[204:207], v[248:251]
    v_mfma_f32_16x16x32_bf16 v[252:255], v[124:127], v[204:207], v[252:255]
    s_waitcnt lgkmcnt(1)
    s_nop 0
    v_mfma_f32_16x16x32_bf16 v[224:227], v[128:131], v[208:211], v[224:227]
    v_mfma_f32_16x16x32_bf16 v[228:231], v[132:135], v[208:211], v[228:231]
    v_mfma_f32_16x16x32_bf16 v[232:235], v[136:139], v[208:211], v[232:235]
    v_mfma_f32_16x16x32_bf16 v[236:239], v[140:143], v[208:211], v[236:239]
    v_mfma_f32_16x16x32_bf16 v[240:243], v[144:147], v[208:211], v[240:243]
    v_mfma_f32_16x16x32_bf16 v[244:247], v[148:151], v[208:211], v[244:247]
    v_mfma_f32_16x16x32_bf16 v[248:251], v[152:155], v[208:211], v[248:251]
    v_mfma_f32_16x16x32_bf16 v[252:255], v[156:159], v[208:211], v[252:255]
    s_waitcnt lgkmcnt(0)
    s_nop 0
    v_mfma_f32_16x16x32_bf16 v[224:227], v[160:163], v[212:215], v[224:227]
    v_mfma_f32_16x16x32_bf16 v[228:231], v[164:167], v[212:215], v[228:231]
    v_mfma_f32_16x16x32_bf16 v[232:235], v[168:171], v[212:215], v[232:235]
    v_mfma_f32_16x16x32_bf16 v[236:239], v[172:175], v[212:215], v[236:239]
    v_mfma_f32_16x16x32_bf16 v[240:243], v[176:179], v[212:215], v[240:243]
    v_mfma_f32_16x16x32_bf16 v[244:247], v[180:183], v[212:215], v[244:247]
    v_mfma_f32_16x16x32_bf16 v[248:251], v[184:187], v[212:215], v[248:251]
    v_mfma_f32_16x16x32_bf16 v[252:255], v[188:191], v[212:215], v[252:255]
    v_readfirstlane_b32 s60, v12
    s_mov_b64 exec, s[52:53]
    ds_write_b128 v28, v[224:227] offset:0
    ds_write_b128 v28, v[228:231] offset:64
    ds_write_b128 v28, v[232:235] offset:128
    ds_write_b128 v28, v[236:239] offset:192
    ds_write_b128 v28, v[240:243] offset:256
    ds_write_b128 v28, v[244:247] offset:320
    ds_write_b128 v28, v[248:251] offset:384
    ds_write_b128 v28, v[252:255] offset:448
    v_mov_b32 v8, 64
    v_mov_b32 v9, 1
    s_mov_b64 exec, 1
    ds_add_u32 v8, v9 offset:4
    s_mov_b64 exec, -1
    s_cmp_ge_u32 s3, 2
    s_cbranch_scc1 FF_w13_b3
    v_mov_b32_e64 v8, 64
    s_mov_b32 s59, 262144
FF_s2:
    ds_read_b32 v9, v8 offset:4
    s_waitcnt lgkmcnt(0)
    v_cmp_ne_u32 vcc, 4, v9
    s_nop 0
    s_cbranch_vccz FF_s2_ok
    s_sleep 1
    s_sub_u32 s59, s59, 1
    s_cmp_lg_u32 s59, 0
    s_cbranch_scc1 FF_s2
FF_s2_ok:
    v_and_b32 v8, 7, v2
    v_lshlrev_b32 v8, 4, v8
    v_lshrrev_b32 v9, 3, v2
    v_add_lshl_u32 v8, v8, v9, 2
    s_lshl_b32 s50, s3, 9
    s_add_u32 s50, s50, 1024
    v_add_u32 v8, s50, v8
    v_add_u32 v9, 32, v8
    ds_read2st64_b32 v[32:33], v8 offset0:0 offset1:4
    ds_read2st64_b32 v[36:37], v9 offset0:0 offset1:4
    ds_read2st64_b32 v[34:35], v8 offset0:8 offset1:12
    ds_read2st64_b32 v[38:39], v9 offset0:8 offset1:12
    s_lshl_b32 s50, s3, 7
    s_add_u32 s50, s50, 8192
    v_lshl_add_u32 v7, v2, 1, s50
    s_waitcnt lgkmcnt(0)
    v_pk_add_f32 v[32:33], v[32:33], v[34:35]
    v_pk_add_f32 v[36:37], v[36:37], v[38:39]
    v_add_f32 v32, v32, v33
    v_add_f32 v36, v36, v37
    v_cvt_pk_bf16_f32 v33, v32, v36
    v_lshlrev_b32 v32, 16, v33
    v_and_b32 v36, s7, v33
    v_mul_f32 v10, 0xbfb8aa3b, v32
    v_exp_f32 v10, v10
    s_nop 0
    v_add_f32 v10, 1.0, v10
    v_rcp_f32 v10, v10
    s_nop 0
    v_mul_f32 v10, v10, v32
    v_cvt_pk_bf16_f32 v10, v10, v10
    v_and_b32 v10, s7, v10
    v_mul_f32 v10, v10, v36
    v_cvt_pk_bf16_f32 v10, v10, v10
    ds_write_b16 v7, v10
    s_waitcnt lgkmcnt(0)
FF_w13_b3:
    s_barrier
    s_barrier
    s_cmp_ge_u32 s3, 2
    s_cbranch_scc1 FF_ep
    s_cmp_ge_u32 s44, 20
    s_cbranch_scc1 FF_end
    s_lshl_b32 s50, s3, 2
    s_add_u32 s50, s50, 8
    v_mov_b32 v8, s50
    ds_read_b32 v15, v8
    v_mul_u32_u24 v14, 61440, v3
    v_lshl_add_u32 v14, v6, 4, v14
    s_waitcnt lgkmcnt(0)
    v_and_b32 v15, s7, v15
    v_ashrrev_i32 v13, 31, v15
    v_not_b32 v13, v13
    v_or_b32 v13, 0x80000000, v13
    v_xor_b32 v15, v15, v13
    v_and_b32 v15, s7, v15
    v_mul_f32 v15, 0xbfb8aa3b, v15
    v_exp_f32 v15, v15
    s_nop 0
    v_add_f32 v15, 1.0, v15
    v_rcp_f32 v15, v15
    s_nop 0
    v_cvt_pk_bf16_f32 v15, v15, v15
    v_and_b32 v15, s7, v15
    s_mov_b32 s59, 262144
FF_yp:
    s_lshl_b32 s51, s44, 8
    s_mul_i32 s50, s3, 5120
    s_add_u32 s51, s51, s50
    s_add_u32 s51, s51, 0x20000
    buffer_load_dwordx4 v[16:19], v14, s[16:19], s51 offen sc1
    s_add_u32 s51, s51, 10240
    buffer_load_dwordx4 v[20:23], v14, s[16:19], s51 offen sc1
    s_add_u32 s51, s51, 10240
    buffer_load_dwordx4 v[24:27], v14, s[16:19], s51 offen sc1
    s_add_u32 s51, s51, 10240
    buffer_load_dwordx4 v[28:31], v14, s[16:19], s51 offen sc1
    s_add_u32 s51, s51, 10240
    buffer_load_dwordx4 v[32:35], v14, s[16:19], s51 offen sc1
    s_add_u32 s51, s51, 10240
    buffer_load_dwordx4 v[36:39], v14, s[16:19], s51 offen sc1
    s_waitcnt vmcnt(0)
    v_mov_b32 v10, 0
    v_xor_b32 v11, s60, v17
    v_or_b32 v10, v10, v11
    v_xor_b32 v11, s60, v19
    v_or_b32 v10, v10, v11
    v_xor_b32 v11, s60, v21
    v_or_b32 v10, v10, v11
    v_xor_b32 v11, s60, v23
    v_or_b32 v10, v10, v11
    v_xor_b32 v11, s60, v25
    v_or_b32 v10, v10, v11
    v_xor_b32 v11, s60, v27
    v_or_b32 v10, v10, v11
    v_xor_b32 v11, s60, v29
    v_or_b32 v10, v10, v11
    v_xor_b32 v11, s60, v31
    v_or_b32 v10, v10, v11
    v_xor_b32 v11, s60, v33
    v_or_b32 v10, v10, v11
    v_xor_b32 v11, s60, v35
    v_or_b32 v10, v10, v11
    v_xor_b32 v11, s60, v37
    v_or_b32 v10, v10, v11
    v_xor_b32 v11, s60, v39
    v_or_b32 v10, v10, v11
    v_cmp_ne_u32 vcc, 0, v10
    s_nop 0
    s_cbranch_vccz FF_yok
    s_sleep 8
    s_sub_u32 s59, s59, 1
    s_cmp_lg_u32 s59, 0
    s_cbranch_scc1 FF_yp
FF_yok:
    v_add_f32 v16, v16, v20
    v_add_f32 v18, v18, v22
    v_add_f32 v16, v16, v24
    v_add_f32 v18, v18, v26
    v_add_f32 v16, v16, v28
    v_add_f32 v18, v18, v30
    v_add_f32 v16, v16, v32
    v_add_f32 v18, v18, v34
    v_add_f32 v16, v16, v36
    v_add_f32 v18, v18, v38
    v_mov_b32 v20, v16
    v_mov_b32 v19, v18
    s_nop 0
    v_permlane32_swap_b32 v16, v20
    v_permlane32_swap_b32 v18, v19
    v_add_f32 v16, v16, v20
    v_add_f32 v18, v18, v19
    v_mov_b32 v20, v16
    v_mov_b32 v19, v18
    s_nop 0
    v_permlane16_swap_b32 v16, v20
    v_permlane16_swap_b32 v18, v19
    v_add_f32 v16, v16, v20
    v_add_f32 v18, v18, v19
    v_cvt_pk_bf16_f32 v16, v16, v16
    v_and_b32 v16, s7, v16
    v_cvt_pk_bf16_f32 v18, v18, v18
    v_and_b32 v18, s7, v18
    v_mul_f32 v16, v15, v16
    v_mul_f32 v18, v15, v18
    v_cvt_pk_bf16_f32 v16, v16, v18
    s_lshl_b32 s51, s44, 7
    s_mul_i32 s50, s3, 2560
    s_add_u32 s51, s51, s50
    s_add_u32 s51, s51, 0x1c000
    v_lshlrev_b32 v8, 3, v2
    s_mov_b64 exec, 0xffff
    buffer_store_dwordx2 v[16:17], v8, s[16:19], s51 offen sc1
    s_mov_b64 exec, -1
    s_branch FF_end
FF_ep:
    s_cmp_lg_u32 s3, 2
    s_cbranch_scc1 FF_end
    s_cmp_lg_u32 s44, 23
    s_cbranch_scc1 FF_end
    v_mul_u32_u24 v8, 12, v2
    s_mov_b32 s59, 262144
FF_ek:
    s_sleep 16
    s_mov_b32 s50, 0x1a000
    buffer_load_dwordx3 v[12:14], v8, s[16:19], s50 offen sc1
    v_min_u32_e64 v9, 23, v2
    v_mul_u32_u24 v9, 10240, v9
    s_mov_b32 s50, 0x20004
    buffer_load_dword v15, v9, s[16:19], s50 offen sc1
    s_waitcnt vmcnt(0)
    v_xor_b32 v12, s60, v12
    v_xor_b32 v13, s60, v13
    v_xor_b32 v14, s60, v14
    v_xor_b32 v15, s60, v15
    v_or3_b32 v10, v12, v13, v14
    v_or_b32 v10, v10, v15
    v_cmp_ne_u32 vcc, 0, v10
    s_nop 0
    s_cbranch_vccz FF_eok
    s_sub_u32 s59, s59, 1
    s_cmp_lg_u32 s59, 0
    s_cbranch_scc1 FF_ek
FF_eok:
    v_mov_b32 v10, s60
    s_mov_b32 s6, 0x18000
    s_mov_b64 exec, 1
    buffer_store_dword v10, off, s[16:19], s6 sc1
    s_mov_b64 exec, -1
    s_branch FF_end
K_ffn2:
    s_sub_u32 s44, s5, 29
    s_mul_i32 s46, s4, 3
    s_add_u32 s44, s44, s46
    s_mov_b32 s46, 0x05040100
    s_mov_b32 s47, 0x07060302
    s_cmp_lg_u32 s3, 7
    s_cbranch_scc1 FF_noep
    s_add_u32 s48, s84, 0x18000
    s_addc_u32 s49, s85, 0
    s_load_dword s60, s[48:49], 0
    s_waitcnt lgkmcnt(0)
    s_mul_i32 s60, s60, 1664525
    s_add_u32 s60, s60, 1013904223
FF_noep:
    s_mov_b32 s8, s64
    s_and_b32 s9, s65, 0xffff
    s_mov_b32 s10, 0x280000
    s_mov_b32 s11, 0x20000
    s_mov_b32 s16, s84
    s_nop 0
    s_and_b32 s17, s85, 0xffff
    s_mov_b32 s18, 0x10000000
    s_mov_b32 s19, 0x20000
    s_mov_b32 s40, s78
    s_nop 0
    s_and_b32 s41, s79, 0xffff
    s_mov_b32 s42, 0x1e0000
    s_mov_b32 s43, 0x20000
    s_sub_u32 s48, s3, 4
    s_mul_i32 s54, s44, 81920
    s_lshl_b32 s55, s48, 8
    s_add_u32 s54, s54, s55
    v_mul_u32_u24 v24, 10240, v3
    v_lshl_add_u32 v24, v6, 4, v24
    s_cmp_eq_u32 s3, 7
    s_cbranch_scc1 FF_top
    v_mov_b32 v8, 64
    s_mov_b32 s59, 262144
FF_s3:
    ds_read_b32 v9, v8 offset:8
    s_waitcnt lgkmcnt(0)
    v_cmp_ne_u32_e64 vcc, 1, v9
    s_nop 0
    s_cbranch_vccz FF_s3_ok
    s_sleep 4
    s_sub_u32 s59, s59, 1
    s_cmp_lg_u32 s59, 0
    s_cbranch_scc1 FF_s3
FF_s3_ok:
    s_add_u32 s55, s54, 0
    buffer_load_dwordx4 v[64:67], v24, s[40:43], s55 offen offset:0
    buffer_load_dwordx4 v[68:71], v24, s[40:43], s55 offen offset:1280
    buffer_load_dwordx4 v[72:75], v24, s[40:43], s55 offen offset:2560
    buffer_load_dwordx4 v[76:79], v24, s[40:43], s55 offen offset:3840
    s_add_u32 s55, s54, 5120
    buffer_load_dwordx4 v[80:83], v24, s[40:43], s55 offen offset:0
    buffer_load_dwordx4 v[84:87], v24, s[40:43], s55 offen offset:1280
    buffer_load_dwordx4 v[88:91], v24, s[40:43], s55 offen offset:2560
    buffer_load_dwordx4 v[92:95], v24, s[40:43], s55 offen offset:3840
    s_add_u32 s55, s54, 40960
    buffer_load_dwordx4 v[96:99], v24, s[40:43], s55 offen offset:0
    buffer_load_dwordx4 v[100:103], v24, s[40:43], s55 offen offset:1280
    buffer_load_dwordx4 v[104:107], v24, s[40:43], s55 offen offset:2560
    buffer_load_dwordx4 v[108:111], v24, s[40:43], s55 offen offset:3840
    s_add_u32 s55, s54, 46080
    buffer_load_dwordx4 v[112:115], v24, s[40:43], s55 offen offset:0
    buffer_load_dwordx4 v[116:119], v24, s[40:43], s55 offen offset:1280
    buffer_load_dwordx4 v[120:123], v24, s[40:43], s55 offen offset:2560
    buffer_load_dwordx4 v[124:127], v24, s[40:43], s55 offen offset:3840
    s_cmp_lg_u32 s3, 4
    s_cbranch_scc1 FF_b1
    s_add_u32 s55, s54, 1024
    buffer_load_dwordx4 v[128:131], v24, s[40:43], s55 offen offset:0
    buffer_load_dwordx4 v[132:135], v24, s[40:43], s55 offen offset:1280
    buffer_load_dwordx4 v[136:139], v24, s[40:43], s55 offen offset:2560
    buffer_load_dwordx4 v[140:143], v24, s[40:43], s55 offen offset:3840
    s_add_u32 s55, s54, 6144
    buffer_load_dwordx4 v[144:147], v24, s[40:43], s55 offen offset:0
    buffer_load_dwordx4 v[148:151], v24, s[40:43], s55 offen offset:1280
    buffer_load_dwordx4 v[152:155], v24, s[40:43], s55 offen offset:2560
    buffer_load_dwordx4 v[156:159], v24, s[40:43], s55 offen offset:3840
    s_add_u32 s55, s54, 41984
    buffer_load_dwordx4 v[160:163], v24, s[40:43], s55 offen offset:0
    buffer_load_dwordx4 v[164:167], v24, s[40:43], s55 offen offset:1280
    buffer_load_dwordx4 v[168:171], v24, s[40:43], s55 offen offset:2560
    buffer_load_dwordx4 v[172:175], v24, s[40:43], s55 offen offset:3840
    s_add_u32 s55, s54, 47104
    buffer_load_dwordx4 v[176:179], v24, s[40:43], s55 offen offset:0
    buffer_load_dwordx4 v[180:183], v24, s[40:43], s55 offen offset:1280
    buffer_load_dwordx4 v[184:187], v24, s[40:43], s55 offen offset:2560
    buffer_load_dwordx4 v[188:191], v24, s[40:43], s55 offen offset:3840
    s_branch FF_b1
FF_top:
    v_mov_b32 v8, 64
    s_mov_b32 s59, 262144
FF_s0:
    ds_read_b32 v9, v8 offset:12
    s_waitcnt lgkmcnt(0)
    v_cmp_ne_u32 vcc, 1, v9
    s_nop 0
    s_cbranch_vccz FF_s0_ok
    s_sleep 4
    s_sub_u32 s59, s59, 1
    s_cmp_lg_u32 s59, 0
    s_cbranch_scc1 FF_s0
FF_s0_ok:
    s_setprio 3
    v_lshlrev_b32 v8, 4, v2
    s_cmp_lg_u32 s44, 0
    s_cbranch_scc1 FF_get
    s_mov_b32 s50, 0x8000
    s_mov_b32 s59, 262144
FF_kp:
    buffer_load_dwordx4 v[32:35], v8, s[16:19], s50 offen offset:0 sc1
    buffer_load_dwordx4 v[36:39], v8, s[16:19], s50 offen offset:1024 sc1
    buffer_load_dwordx4 v[40:43], v8, s[16:19], s50 offen offset:2048 sc1
    buffer_load_dwordx4 v[44:47], v8, s[16:19], s50 offen offset:3072 sc1
    s_waitcnt vmcnt(0)
    v_mov_b32 v10, 0
    v_xor_b32 v11, s60, v33
    v_or_b32 v10, v10, v11
    v_xor_b32 v11, s60, v35
    v_or_b32 v10, v10, v11
    v_xor_b32 v11, s60, v37
    v_or_b32 v10, v10, v11
    v_xor_b32 v11, s60, v39
    v_or_b32 v10, v10, v11
    v_xor_b32 v11, s60, v41
    v_or_b32 v10, v10, v11
    v_xor_b32 v11, s60, v43
    v_or_b32 v10, v10, v11
    v_xor_b32 v11, s60, v45
    v_or_b32 v10, v10, v11
    v_xor_b32 v11, s60, v47
    v_or_b32 v10, v10, v11
    v_cmp_ne_u32 vcc, 0, v10
    s_nop 0
    s_cbranch_vccz FF_kok
    s_sleep 4
    s_sub_u32 s59, s59, 1
    s_cmp_lg_u32 s59, 0
    s_cbranch_scc1 FF_kp
FF_kok:
    v_mov_b32 v10, v32
    v_mov_b32 v11, v34
    v_med3_u32 v11, v10, v11, v36
    v_max_u32 v10, v10, v36
    v_med3_u32 v11, v10, v11, v38
    v_max_u32 v10, v10, v38
    v_med3_u32 v11, v10, v11, v40
    v_max_u32 v10, v10, v40
    v_med3_u32 v11, v10, v11, v42
    v_max_u32 v10, v10, v42
    v_med3_u32 v11, v10, v11, v44
    v_max_u32 v10, v10, v44
    v_med3_u32 v11, v10, v11, v46
    v_max_u32 v10, v10, v46
    v_mov_b32 v12, v10
    s_nop 1
    v_max_u32_dpp v12, v12, v12 row_shr:1 row_mask:0xf bank_mask:0xf bound_ctrl:1
    s_nop 1
    v_max_u32_dpp v12, v12, v12 row_shr:2 row_mask:0xf bank_mask:0xf bound_ctrl:1
    s_nop 1
    v_max_u32_dpp v12, v12, v12 row_shr:4 row_mask:0xf bank_mask:0xf bound_ctrl:1
    s_nop 1
    v_max_u32_dpp v12, v12, v12 row_shr:8 row_mask:0xf bank_mask:0xf bound_ctrl:1
    s_nop 1
    v_max_u32_dpp v12, v12, v12 row_bcast:15 row_mask:0xa bank_mask:0xf
    s_nop 1
    v_max_u32_dpp v12, v12, v12 row_bcast:31 row_mask:0xc bank_mask:0xf
    s_nop 0
    v_readlane_b32 s50, v12, 63
    s_nop 1
    v_cmp_eq_u32 vcc, s50, v10
    s_nop 1
    v_cndmask_b32 v12, v10, v11, vcc
    s_nop 1
    v_max_u32_dpp v12, v12, v12 row_shr:1 row_mask:0xf bank_mask:0xf bound_ctrl:1
    s_nop 1
    v_max_u32_dpp v12, v12, v12 row_shr:2 row_mask:0xf bank_mask:0xf bound_ctrl:1
    s_nop 1
    v_max_u32_dpp v12, v12, v12 row_shr:4 row_mask:0xf bank_mask:0xf bound_ctrl:1
    s_nop 1
    v_max_u32_dpp v12, v12, v12 row_shr:8 row_mask:0xf bank_mask:0xf bound_ctrl:1
    s_nop 1
    v_max_u32_dpp v12, v12, v12 row_bcast:15 row_mask:0xa bank_mask:0xf
    s_nop 1
    v_max_u32_dpp v12, v12, v12 row_bcast:31 row_mask:0xc bank_mask:0xf
    s_nop 0
    v_readlane_b32 s51, v12, 63
    s_and_b32 s52, s50, 0xffff
    s_lshl_b32 s53, s51, 16
    s_or_b32 s52, s52, s53
    s_lshr_b32 s53, s50, 16
    s_and_b32 s56, s51, 0xffff0000
    s_or_b32 s53, s53, s56
    v_mov_b32 v20, s52
    v_mov_b32 v21, s60
    v_mov_b32 v22, s53
    v_mov_b32_e64 v23, s60
    s_mov_b64 exec, 1
    s_mov_b32 s6, 0x10000
    buffer_store_dwordx4 v[20:23], off, s[16:19], s6 sc1
    s_mov_b64 exec, -1
    s_branch FF_have
FF_get:
    s_mov_b32 s59, 262144
FF_tp:
    s_mov_b32 s6, 0x10000
    buffer_load_dwordx4 v[20:23], off, s[16:19], s6 sc1
    s_waitcnt vmcnt(0)
    v_xor_b32 v10, s60, v21
    v_xor_b32 v11, s60, v23
    v_or_b32 v10, v10, v11
    v_cmp_ne_u32 vcc, 0, v10
    s_nop 0
    s_cbranch_vccz FF_tok
    s_sleep 4
    s_sub_u32 s59, s59, 1
    s_cmp_lg_u32 s59, 0
    s_cbranch_scc1 FF_tp
FF_tok:
    v_readfirstlane_b32 s52, v20
    v_readfirstlane_b32 s53, v22
    s_nop 0
    s_lshl_b32 s50, s53, 16
    s_and_b32 s56, s52, 0xffff
    s_or_b32 s50, s50, s56
    s_and_b32 s51, s53, 0xffff0000
    s_lshr_b32 s56, s52, 16
    s_or_b32 s51, s51, s56
FF_have:
    v_mov_b32 v16, s52
    v_mov_b32 v17, s60
    v_mov_b32 v18, s50
    v_mov_b32 v19, s51
    s_and_b32 s56, s50, 0x7ff
    s_lshl_b32 s48, s56, 3
    s_lshr_b32 s57, s56, 10
    s_and_b32 s56, s56, 1023
    s_lshl_b32 s56, s56, 1
    s_add_u32 s56, s56, s57
    s_mul_i32 s62, s56, 1280
    s_and_b32 s56, s51, 0x7ff
    s_lshl_b32 s49, s56, 3
    s_lshr_b32 s57, s56, 10
    s_and_b32 s56, s56, 1023
    s_lshl_b32 s56, s56, 1
    s_add_u32 s56, s56, s57
    s_mul_i32 s63, s56, 1280
    buffer_load_dwordx4 v[160:163], v8, s[8:11], s62 offen
    buffer_load_dwordx4 v[164:167], v8, s[8:11], s63 offen
    v_bfe_u32 v9, v2, 4, 1
    v_cmp_eq_u32 vcc, 0, v9
    v_mov_b32 v10, s62
    v_mov_b32 v11, s63
    v_cndmask_b32 v10, v11, v10, vcc
    v_lshl_add_u32 v10, v6, 4, v10
    buffer_load_dwordx4 v[168:171], v10, s[8:11], 0 offen offset:1024
    buffer_load_dwordx2 v[12:13], off, s[16:19], s48 sc1
    buffer_load_dwordx2 v[14:15], off, s[16:19], s49 sc1
    v_mov_b32 v8, 0
    ds_write_b128 v8, v[16:19]
    v_mov_b32 v11, 1
    ds_write_b32 v8, v11 offset:72
    s_waitcnt vmcnt(0)
    s_mov_b32 s59, 262144
FF_sp:
    v_xor_b32 v16, s60, v13
    v_xor_b32 v17, s60, v15
    v_or_b32 v16, v16, v17
    v_cmp_ne_u32_e64 vcc, 0, v16
    s_nop 0
    s_cbranch_vccz FF_sok
    buffer_load_dwordx2 v[12:13], off, s[16:19], s48 sc1
    buffer_load_dwordx2 v[14:15], off, s[16:19], s49 sc1
    s_waitcnt vmcnt(0)
    s_sub_u32 s59, s59, 1
    s_cmp_lg_u32 s59, 0
    s_cbranch_scc1 FF_sp
FF_sok:
    v_and_b32 v13, s7, v12
    v_rcp_f32 v13, v13
    v_lshlrev_b32 v12, 16, v12
    v_and_b32 v15, s7, v14
    v_rcp_f32 v15, v15
    v_lshlrev_b32 v14, 16, v14
    v_cmp_eq_u32 vcc, 0, v9
    s_nop 1
    v_cndmask_b32 v10, v14, v12, vcc
    v_cndmask_b32 v11, v15, v13, vcc
    v_lshrrev_b32 v25, 2, v2
    v_lshlrev_b32 v25, 6, v25
    v_lshl_add_u32 v25, v5, 2, v25
    v_add_u32 v25, 12288, v25
    v_add_u32 v26, 1280, v25
    v_mul_u32_u24 v27, 1280, v9
    v_lshl_add_u32 v27, v4, 6, v27
    v_lshl_add_u32 v27, v5, 2, v27
    v_add_u32 v27, 13312, v27
    v_lshlrev_b32 v16, 16, v160
    v_and_b32 v17, s7, v160
    v_lshlrev_b32 v18, 16, v161
    v_and_b32 v19, s7, v161
    v_lshlrev_b32 v20, 16, v162
    v_and_b32 v21, s7, v162
    v_lshlrev_b32 v22, 16, v163
    v_and_b32 v23, s7, v163
    v_pk_add_f32 v[16:17], v[16:17], v[12:13] op_sel_hi:[1,0] neg_lo:[0,1] neg_hi:[0,1]
    v_pk_add_f32 v[18:19], v[18:19], v[12:13] op_sel_hi:[1,0] neg_lo:[0,1] neg_hi:[0,1]
    v_pk_add_f32 v[20:21], v[20:21], v[12:13] op_sel_hi:[1,0] neg_lo:[0,1] neg_hi:[0,1]
    v_pk_add_f32 v[22:23], v[22:23], v[12:13] op_sel_hi:[1,0] neg_lo:[0,1] neg_hi:[0,1]
    v_cvt_pk_bf16_f32 v160, v16, v17
    v_cvt_pk_bf16_f32 v161, v18, v19
    v_cvt_pk_bf16_f32 v162, v20, v21
    v_cvt_pk_bf16_f32 v163, v22, v23
    v_lshlrev_b32 v16, 16, v160
    v_and_b32 v17, s7, v160
    v_lshlrev_b32 v18, 16, v161
    v_and_b32 v19, s7, v161
    v_lshlrev_b32 v20, 16, v162
    v_and_b32 v21, s7, v162
    v_lshlrev_b32 v22, 16, v163
    v_and_b32 v23, s7, v163
    v_pk_mul_f32 v[16:17], v[16:17], v[12:13] op_sel:[0,1]
    v_pk_mul_f32 v[18:19], v[18:19], v[12:13] op_sel:[0,1]
    v_pk_mul_f32 v[20:21], v[20:21], v[12:13] op_sel:[0,1]
    v_pk_mul_f32 v[22:23], v[22:23], v[12:13] op_sel:[0,1]
    v_cvt_pk_bf16_f32 v160, v16, v20
    v_cvt_pk_bf16_f32 v161, v17, v21
    v_cvt_pk_bf16_f32 v162, v18, v22
    v_cvt_pk_bf16_f32 v163, v19, v23
    ds_write2_b32 v25, v160, v161 offset0:0 offset1:4
    ds_write2_b32 v25, v162, v163 offset0:8 offset1:12
    v_lshlrev_b32 v16, 16, v164
    v_and_b32 v17, s7, v164
    v_lshlrev_b32 v18, 16, v165
    v_and_b32 v19, s7, v165
    v_lshlrev_b32 v20, 16, v166
    v_and_b32 v21, s7, v166
    v_lshlrev_b32 v22, 16, v167
    v_and_b32 v23, s7, v167
    v_pk_add_f32 v[16:17], v[16:17], v[14:15] op_sel_hi:[1,0] neg_lo:[0,1] neg_hi:[0,1]
    v_pk_add_f32 v[18:19], v[18:19], v[14:15] op_sel_hi:[1,0] neg_lo:[0,1] neg_hi:[0,1]
    v_pk_add_f32 v[20:21], v[20:21], v[14:15] op_sel_hi:[1,0] neg_lo:[0,1] neg_hi:[0,1]
    v_pk_add_f32 v[22:23], v[22:23], v[14:15] op_sel_hi:[1,0] neg_lo:[0,1] neg_hi:[0,1]
    v_cvt_pk_bf16_f32 v164, v16, v17
    v_cvt_pk_bf16_f32 v165, v18, v19
    v_cvt_pk_bf16_f32 v166, v20, v21
    v_cvt_pk_bf16_f32 v167, v22, v23
    v_lshlrev_b32 v16, 16, v164
    v_and_b32 v17, s7, v164
    v_lshlrev_b32 v18, 16, v165
    v_and_b32 v19, s7, v165
    v_lshlrev_b32 v20, 16, v166
    v_and_b32 v21, s7, v166
    v_lshlrev_b32 v22, 16, v167
    v_and_b32 v23, s7, v167
    v_pk_mul_f32 v[16:17], v[16:17], v[14:15] op_sel:[0,1]
    v_pk_mul_f32 v[18:19], v[18:19], v[14:15] op_sel:[0,1]
    v_pk_mul_f32 v[20:21], v[20:21], v[14:15] op_sel:[0,1]
    v_pk_mul_f32 v[22:23], v[22:23], v[14:15] op_sel:[0,1]
    v_cvt_pk_bf16_f32 v164, v16, v20
    v_cvt_pk_bf16_f32 v165, v17, v21
    v_cvt_pk_bf16_f32 v166, v18, v22
    v_cvt_pk_bf16_f32 v167, v19, v23
    ds_write2_b32 v26, v164, v165 offset0:0 offset1:4
    ds_write2_b32 v26, v166, v167 offset0:8 offset1:12
    v_lshlrev_b32 v16, 16, v168
    v_and_b32 v17, s7, v168
    v_lshlrev_b32 v18, 16, v169
    v_and_b32 v19, s7, v169
    v_lshlrev_b32 v20, 16, v170
    v_and_b32 v21, s7, v170
    v_lshlrev_b32 v22, 16, v171
    v_and_b32 v23, s7, v171
    v_pk_add_f32 v[16:17], v[16:17], v[10:11] op_sel_hi:[1,0] neg_lo:[0,1] neg_hi:[0,1]
    v_pk_add_f32 v[18:19], v[18:19], v[10:11] op_sel_hi:[1,0] neg_lo:[0,1] neg_hi:[0,1]
    v_pk_add_f32 v[20:21], v[20:21], v[10:11] op_sel_hi:[1,0] neg_lo:[0,1] neg_hi:[0,1]
    v_pk_add_f32 v[22:23], v[22:23], v[10:11] op_sel_hi:[1,0] neg_lo:[0,1] neg_hi:[0,1]
    v_cvt_pk_bf16_f32 v168, v16, v17
    v_cvt_pk_bf16_f32 v169, v18, v19
    v_cvt_pk_bf16_f32 v170, v20, v21
    v_cvt_pk_bf16_f32 v171, v22, v23
    v_lshlrev_b32 v16, 16, v168
    v_and_b32 v17, s7, v168
    v_lshlrev_b32 v18, 16, v169
    v_and_b32 v19, s7, v169
    v_lshlrev_b32 v20, 16, v170
    v_and_b32 v21, s7, v170
    v_lshlrev_b32 v22, 16, v171
    v_and_b32 v23, s7, v171
    v_pk_mul_f32 v[16:17], v[16:17], v[10:11] op_sel:[0,1]
    v_pk_mul_f32 v[18:19], v[18:19], v[10:11] op_sel:[0,1]
    v_pk_mul_f32 v[20:21], v[20:21], v[10:11] op_sel:[0,1]
    v_pk_mul_f32 v[22:23], v[22:23], v[10:11] op_sel:[0,1]
    v_cvt_pk_bf16_f32 v168, v16, v20
    v_cvt_pk_bf16_f32 v169, v17, v21
    v_cvt_pk_bf16_f32 v170, v18, v22
    v_cvt_pk_bf16_f32 v171, v19, v23
    ds_write2_b32 v27, v168, v169 offset0:0 offset1:4
    ds_write2_b32 v27, v170, v171 offset0:8 offset1:12
    v_mov_b32 v8, 64
    v_mov_b32 v9, 1
    ds_write_b32 v8, v9
    s_setprio 0
    s_sub_u32 s48, s3, 4
    s_add_u32 s55, s54, 0
    s_nop 0
    buffer_load_dwordx4 v[64:67], v24, s[40:43], s55 offen offset:0
    buffer_load_dwordx4 v[68:71], v24, s[40:43], s55 offen offset:1280
    buffer_load_dwordx4 v[72:75], v24, s[40:43], s55 offen offset:2560
    buffer_load_dwordx4 v[76:79], v24, s[40:43], s55 offen offset:3840
    s_add_u32 s55, s54, 5120
    buffer_load_dwordx4 v[80:83], v24, s[40:43], s55 offen offset:0
    buffer_load_dwordx4 v[84:87], v24, s[40:43], s55 offen offset:1280
    buffer_load_dwordx4 v[88:91], v24, s[40:43], s55 offen offset:2560
    buffer_load_dwordx4 v[92:95], v24, s[40:43], s55 offen offset:3840
    s_add_u32 s55, s54, 40960
    buffer_load_dwordx4 v[96:99], v24, s[40:43], s55 offen offset:0
    buffer_load_dwordx4 v[100:103], v24, s[40:43], s55 offen offset:1280
    buffer_load_dwordx4 v[104:107], v24, s[40:43], s55 offen offset:2560
    buffer_load_dwordx4 v[108:111], v24, s[40:43], s55 offen offset:3840
    s_add_u32 s55, s54, 46080
    buffer_load_dwordx4 v[112:115], v24, s[40:43], s55 offen offset:0
    buffer_load_dwordx4 v[116:119], v24, s[40:43], s55 offen offset:1280
    buffer_load_dwordx4 v[120:123], v24, s[40:43], s55 offen offset:2560
    buffer_load_dwordx4 v[124:127], v24, s[40:43], s55 offen offset:3840
FF_b1:
    s_setprio 0
    v_and_b32 v26, 1, v2
    v_lshlrev_b32_e64 v26, 7, v26
    v_lshl_add_u32 v26, v3, 4, v26
    v_add_u32 v26, 8192, v26
    s_lshl_b32 s50, s48, 10
    s_add_u32 s50, s50, 16384
    v_lshlrev_b32 v29, 9, v6
    v_lshl_add_u32 v29, v3, 4, v29
    v_add_u32 v29, s50, v29
    v_and_b32 v30, 3, v2
    v_lshlrev_b32 v30, 5, v30
    v_lshrrev_b32 v31, 2, v2
    v_add_lshl_u32 v30, v30, v31, 2
    v_add_u32 v30, s50, v30
    v_lshlrev_b32 v31, 4, v2
    s_mov_b32 s52, 0x30003
    s_mov_b32 s53, 0x30003
    s_mul_i32 s56, s44, 10240
    s_lshl_b32 s50, s48, 10
    s_add_u32 s56, s56, s50
    s_add_u32 s56, s56, 0x20000
    s_cmp_eq_u32 s3, 4
    s_cbranch_scc1 FF_d4
    s_waitcnt vmcnt(8)
    s_nop 0
    v_perm_b32 v32, v68, v64, s46
    v_perm_b32 v33, v76, v72, s46
    v_perm_b32 v34, v84, v80, s46
    v_perm_b32 v35, v92, v88, s46
    v_perm_b32 v36, v68, v64, s47
    v_perm_b32 v37, v76, v72, s47
    v_perm_b32 v38, v84, v80, s47
    v_perm_b32 v39, v92, v88, s47
    v_perm_b32 v40, v69, v65, s46
    v_perm_b32 v41, v77, v73, s46
    v_perm_b32 v42, v85, v81, s46
    v_perm_b32 v43, v93, v89, s46
    v_perm_b32 v44, v69, v65, s47
    v_perm_b32 v45, v77, v73, s47
    v_perm_b32 v46, v85, v81, s47
    v_perm_b32 v47, v93, v89, s47
    v_perm_b32 v48, v70, v66, s46
    v_perm_b32 v49, v78, v74, s46
    v_perm_b32 v50, v86, v82, s46
    v_perm_b32 v51, v94, v90, s46
    v_perm_b32 v52, v70, v66, s47
    v_perm_b32 v53, v78, v74, s47
    v_perm_b32 v54, v86, v82, s47
    v_perm_b32 v55, v94, v90, s47
    v_perm_b32 v56, v71, v67, s46
    v_perm_b32 v57, v79, v75, s46
    v_perm_b32 v58, v87, v83, s46
    v_perm_b32 v59, v95, v91, s46
    v_perm_b32 v60, v71, v67, s47
    v_perm_b32 v61, v79, v75, s47
    v_perm_b32 v62, v87, v83, s47
    v_perm_b32 v63, v95, v91, s47
    s_waitcnt vmcnt(0)
    s_nop 0
    v_perm_b32 v64, v100, v96, s46
    v_perm_b32 v65, v108, v104, s46
    v_perm_b32 v66, v116, v112, s46
    v_perm_b32 v67, v124, v120, s46
    v_perm_b32 v68, v100, v96, s47
    v_perm_b32 v69, v108, v104, s47
    v_perm_b32 v70, v116, v112, s47
    v_perm_b32 v71, v124, v120, s47
    v_perm_b32 v72, v101, v97, s46
    v_perm_b32 v73, v109, v105, s46
    v_perm_b32 v74, v117, v113, s46
    v_perm_b32 v75, v125, v121, s46
    v_perm_b32 v76, v101, v97, s47
    v_perm_b32 v77, v109, v105, s47
    v_perm_b32 v78, v117, v113, s47
    v_perm_b32 v79, v125, v121, s47
    v_perm_b32 v80, v102, v98, s46
    v_perm_b32 v81, v110, v106, s46
    v_perm_b32 v82, v118, v114, s46
    v_perm_b32 v83, v126, v122, s46
    v_perm_b32 v84, v102, v98, s47
    v_perm_b32 v85, v110, v106, s47
    v_perm_b32 v86, v118, v114, s47
    v_perm_b32 v87, v126, v122, s47
    v_perm_b32 v88, v103, v99, s46
    v_perm_b32 v89, v111, v107, s46
    v_perm_b32 v90, v119, v115, s46
    v_perm_b32 v91, v127, v123, s46
    v_perm_b32 v92, v103, v99, s47
    v_perm_b32 v93, v111, v107, s47
    v_perm_b32 v94, v119, v115, s47
    v_perm_b32 v95, v127, v123, s47
    s_branch FF_d2
FF_d4:
    s_waitcnt vmcnt(24)
    v_perm_b32 v32, v68, v64, s46
    v_perm_b32 v33, v76, v72, s46
    v_perm_b32 v34, v84, v80, s46
    v_perm_b32 v35, v92, v88, s46
    v_perm_b32 v36, v68, v64, s47
    v_perm_b32 v37, v76, v72, s47
    v_perm_b32 v38, v84, v80, s47
    v_perm_b32 v39, v92, v88, s47
    v_perm_b32 v40, v69, v65, s46
    v_perm_b32 v41, v77, v73, s46
    v_perm_b32 v42, v85, v81, s46
    v_perm_b32 v43, v93, v89, s46
    v_perm_b32 v44, v69, v65, s47
    v_perm_b32 v45, v77, v73, s47
    v_perm_b32 v46, v85, v81, s47
    v_perm_b32 v47, v93, v89, s47
    v_perm_b32 v48, v70, v66, s46
    v_perm_b32 v49, v78, v74, s46
    v_perm_b32 v50, v86, v82, s46
    v_perm_b32 v51, v94, v90, s46
    v_perm_b32 v52, v70, v66, s47
    v_perm_b32 v53, v78, v74, s47
    v_perm_b32 v54, v86, v82, s47
    v_perm_b32 v55, v94, v90, s47
    v_perm_b32 v56, v71, v67, s46
    v_perm_b32 v57, v79, v75, s46
    v_perm_b32 v58, v87, v83, s46
    v_perm_b32 v59, v95, v91, s46
    v_perm_b32 v60, v71, v67, s47
    v_perm_b32 v61, v79, v75, s47
    v_perm_b32 v62, v87, v83, s47
    v_perm_b32 v63, v95, v91, s47
    s_waitcnt vmcnt(16)
    s_nop 0
    v_perm_b32 v64, v100, v96, s46
    v_perm_b32 v65, v108, v104, s46
    v_perm_b32 v66, v116, v112, s46
    v_perm_b32 v67, v124, v120, s46
    v_perm_b32 v68, v100, v96, s47
    v_perm_b32 v69, v108, v104, s47
    v_perm_b32 v70, v116, v112, s47
    v_perm_b32 v71, v124, v120, s47
    v_perm_b32 v72, v101, v97, s46
    v_perm_b32 v73, v109, v105, s46
    v_perm_b32 v74, v117, v113, s46
    v_perm_b32 v75, v125, v121, s46
    v_perm_b32 v76, v101, v97, s47
    v_perm_b32 v77, v109, v105, s47
    v_perm_b32 v78, v117, v113, s47
    v_perm_b32 v79, v125, v121, s47
    v_perm_b32 v80, v102, v98, s46
    v_perm_b32 v81, v110, v106, s46
    v_perm_b32 v82, v118, v114, s46
    v_perm_b32 v83, v126, v122, s46
    v_perm_b32 v84, v102, v98, s47
    v_perm_b32 v85, v110, v106, s47
    v_perm_b32 v86, v118, v114, s47
    v_perm_b32 v87, v126, v122, s47
    v_perm_b32 v88, v103, v99, s46
    v_perm_b32 v89, v111, v107, s46
    v_perm_b32 v90, v119, v115, s46
    v_perm_b32 v91, v127, v123, s46
    v_perm_b32 v92, v103, v99, s47
    v_perm_b32 v93, v111, v107, s47
    v_perm_b32 v94, v119, v115, s47
    v_perm_b32 v95, v127, v123, s47
    s_waitcnt vmcnt(8)
    s_nop 0
    v_perm_b32 v96, v132, v128, s46
    v_perm_b32 v97, v140, v136, s46
    v_perm_b32 v98, v148, v144, s46
    v_perm_b32 v99, v156, v152, s46
    v_perm_b32 v100, v132, v128, s47
    v_perm_b32 v101, v140, v136, s47
    v_perm_b32 v102, v148, v144, s47
    v_perm_b32 v103, v156, v152, s47
    v_perm_b32 v104, v133, v129, s46
    v_perm_b32 v105, v141, v137, s46
    v_perm_b32 v106, v149, v145, s46
    v_perm_b32 v107, v157, v153, s46
    v_perm_b32 v108, v133, v129, s47
    v_perm_b32 v109, v141, v137, s47
    v_perm_b32 v110, v149, v145, s47
    v_perm_b32 v111, v157, v153, s47
    v_perm_b32 v112, v134, v130, s46
    v_perm_b32 v113, v142, v138, s46
    v_perm_b32 v114, v150, v146, s46
    v_perm_b32 v115, v158, v154, s46
    v_perm_b32 v116, v134, v130, s47
    v_perm_b32 v117, v142, v138, s47
    v_perm_b32 v118, v150, v146, s47
    v_perm_b32 v119, v158, v154, s47
    v_perm_b32 v120, v135, v131, s46
    v_perm_b32 v121, v143, v139, s46
    v_perm_b32 v122, v151, v147, s46
    v_perm_b32 v123, v159, v155, s46
    v_perm_b32 v124, v135, v131, s47
    v_perm_b32 v125, v143, v139, s47
    v_perm_b32 v126, v151, v147, s47
    v_perm_b32 v127, v159, v155, s47
    s_waitcnt vmcnt(0)
    s_nop 0
    v_perm_b32 v128, v164, v160, s46
    v_perm_b32 v129, v172, v168, s46
    v_perm_b32 v130, v180, v176, s46
    v_perm_b32 v131, v188, v184, s46
    v_perm_b32 v132, v164, v160, s47
    v_perm_b32 v133, v172, v168, s47
    v_perm_b32 v134, v180, v176, s47
    v_perm_b32 v135, v188, v184, s47
    v_perm_b32 v136, v165, v161, s46
    v_perm_b32 v137, v173, v169, s46
    v_perm_b32 v138, v181, v177, s46
    v_perm_b32 v139, v189, v185, s46
    v_perm_b32 v140, v165, v161, s47
    v_perm_b32 v141, v173, v169, s47
    v_perm_b32 v142, v181, v177, s47
    v_perm_b32 v143, v189, v185, s47
    v_perm_b32 v144, v166, v162, s46
    v_perm_b32 v145, v174, v170, s46
    v_perm_b32 v146, v182, v178, s46
    v_perm_b32 v147, v190, v186, s46
    v_perm_b32 v148, v166, v162, s47
    v_perm_b32 v149, v174, v170, s47
    v_perm_b32 v150, v182, v178, s47
    v_perm_b32 v151, v190, v186, s47
    v_perm_b32 v152, v167, v163, s46
    v_perm_b32 v153, v175, v171, s46
    v_perm_b32 v154, v183, v179, s46
    v_perm_b32 v155, v191, v187, s46
    v_perm_b32 v156, v167, v163, s47
    v_perm_b32 v157, v175, v171, s47
    v_perm_b32 v158, v183, v179, s47
    v_perm_b32 v159, v191, v187, s47
FF_d2:
    s_barrier
    v_mov_b32 v8, 0
    ds_read_b32 v9, v8 offset:4
    ds_read_b128 v[16:19], v26
    ds_read_b128 v[20:23], v26 offset:64
    s_waitcnt lgkmcnt(2)
    v_mov_b32 v11, v9
    v_mov_b32 v13, v9
    v_mov_b32_e64 v15, v9
    s_waitcnt lgkmcnt(0)
    v_mfma_f32_16x16x32_bf16 v[224:227], v[32:35], v[16:19], 0
    v_mfma_f32_16x16x32_bf16 v[228:231], v[36:39], v[16:19], 0
    v_mfma_f32_16x16x32_bf16 v[232:235], v[40:43], v[16:19], 0
    v_mfma_f32_16x16x32_bf16 v[236:239], v[44:47], v[16:19], 0
    v_mfma_f32_16x16x32_bf16 v[240:243], v[48:51], v[16:19], 0
    v_mfma_f32_16x16x32_bf16 v[244:247], v[52:55], v[16:19], 0
    v_mfma_f32_16x16x32_bf16 v[248:251], v[56:59], v[16:19], 0
    v_mfma_f32_16x16x32_bf16 v[252:255], v[60:63], v[16:19], 0
    v_mfma_f32_16x16x32_bf16 v[224:227], v[64:67], v[20:23], v[224:227]
    v_mfma_f32_16x16x32_bf16 v[228:231], v[68:71], v[20:23], v[228:231]
    v_mfma_f32_16x16x32_bf16 v[232:235], v[72:75], v[20:23], v[232:235]
    v_mfma_f32_16x16x32_bf16 v[236:239], v[76:79], v[20:23], v[236:239]
    v_mfma_f32_16x16x32_bf16 v[240:243], v[80:83], v[20:23], v[240:243]
    v_mfma_f32_16x16x32_bf16 v[244:247], v[84:87], v[20:23], v[244:247]
    v_mfma_f32_16x16x32_bf16 v[248:251], v[88:91], v[20:23], v[248:251]
    v_mfma_f32_16x16x32_bf16 v[252:255], v[92:95], v[20:23], v[252:255]
    s_mov_b64 exec, s[52:53]
    s_nop 0
    ds_write_b128 v29, v[224:227] offset:0
    ds_write_b128 v29, v[228:231] offset:64
    ds_write_b128 v29, v[232:235] offset:128
    ds_write_b128 v29, v[236:239] offset:192
    ds_write_b128 v29, v[240:243] offset:256
    ds_write_b128 v29, v[244:247] offset:320
    ds_write_b128 v29, v[248:251] offset:384
    ds_write_b128 v29, v[252:255] offset:448
    s_mov_b64 exec, -1
    s_nop 0
    ds_read_b32 v8, v30
    ds_read_b32 v10, v30 offset:64
    ds_read_b32 v12, v30 offset:512
    ds_read_b32 v14, v30 offset:576
    s_add_u32 s50, s56, 0
    s_add_u32 s51, s50, 5120
    s_waitcnt lgkmcnt(2)
    buffer_store_dwordx4 v[8:11], v31, s[16:19], s50 offen sc1
    s_waitcnt lgkmcnt(0)
    buffer_store_dwordx4 v[12:15], v31, s[16:19], s51 offen sc1
    s_cmp_lg_u32 s3, 4
    s_cbranch_scc1 FF_b4
    s_waitcnt lgkmcnt(0)
    v_mfma_f32_16x16x32_bf16 v[224:227], v[96:99], v[16:19], 0
    v_mfma_f32_16x16x32_bf16 v[228:231], v[100:103], v[16:19], 0
    v_mfma_f32_16x16x32_bf16 v[232:235], v[104:107], v[16:19], 0
    v_mfma_f32_16x16x32_bf16 v[236:239], v[108:111], v[16:19], 0
    v_mfma_f32_16x16x32_bf16 v[240:243], v[112:115], v[16:19], 0
    v_mfma_f32_16x16x32_bf16 v[244:247], v[116:119], v[16:19], 0
    v_mfma_f32_16x16x32_bf16 v[248:251], v[120:123], v[16:19], 0
    v_mfma_f32_16x16x32_bf16 v[252:255], v[124:127], v[16:19], 0
    v_mfma_f32_16x16x32_bf16 v[224:227], v[128:131], v[20:23], v[224:227]
    v_mfma_f32_16x16x32_bf16 v[228:231], v[132:135], v[20:23], v[228:231]
    v_mfma_f32_16x16x32_bf16 v[232:235], v[136:139], v[20:23], v[232:235]
    v_mfma_f32_16x16x32_bf16 v[236:239], v[140:143], v[20:23], v[236:239]
    v_mfma_f32_16x16x32_bf16 v[240:243], v[144:147], v[20:23], v[240:243]
    v_mfma_f32_16x16x32_bf16 v[244:247], v[148:151], v[20:23], v[244:247]
    v_mfma_f32_16x16x32_bf16 v[248:251], v[152:155], v[20:23], v[248:251]
    v_mfma_f32_16x16x32_bf16 v[252:255], v[156:159], v[20:23], v[252:255]
    s_mov_b64 exec, s[52:53]
    s_nop 0
    ds_write_b128 v29, v[224:227] offset:0
    ds_write_b128 v29, v[228:231] offset:64
    ds_write_b128 v29, v[232:235] offset:128
    ds_write_b128 v29, v[236:239] offset:192
    ds_write_b128 v29, v[240:243] offset:256
    ds_write_b128 v29, v[244:247] offset:320
    ds_write_b128 v29, v[248:251] offset:384
    ds_write_b128 v29, v[252:255] offset:448
    s_mov_b64 exec, -1
    s_nop 0
    ds_read_b32 v8, v30
    ds_read_b32 v10, v30 offset:64
    ds_read_b32 v12, v30 offset:512
    ds_read_b32 v14, v30 offset:576
    s_add_u32 s50, s56, 4096
    s_add_u32 s51, s50, 5120
    s_waitcnt lgkmcnt(2)
    buffer_store_dwordx4 v[8:11], v31, s[16:19], s50 offen sc1
    s_waitcnt lgkmcnt(0)
    buffer_store_dwordx4 v[12:15], v31, s[16:19], s51 offen sc1
FF_b4:
    s_waitcnt vmcnt(0)
    s_barrier
FF_end:
K_end:
    s_endpgm
.section .rodata,"a"
.p2align 6
.amdhsa_kernel parallel_sum__sliding_local_dilated__moe_arch_mod__prompt_kernel
  .amdhsa_next_free_vgpr 256
  .amdhsa_next_free_sgpr 102
  .amdhsa_accum_offset 256
  .amdhsa_group_segment_fixed_size 0
  .amdhsa_kernarg_size 88
  .amdhsa_user_sgpr_count 2
  .amdhsa_user_sgpr_kernarg_segment_ptr 1
  .amdhsa_system_sgpr_workgroup_id_x 1
  .amdhsa_float_denorm_mode_32 3
.end_amdhsa_kernel
```
